```python
import torch

def _softmax(x, axis=-1):
    return torch.softmax(x, dim=axis)

def _gelu(x):
    return torch.nn.functional.gelu(x, approximate='tanh')

def _silu(x):
    return torch.nn.functional.silu(x)

def _sigmoid(x):
    return torch.sigmoid(x)

def _layernorm(x, axis=-1, eps=1e-05):
    m = x.mean(dim=axis, keepdim=True)
    v = x.var(dim=axis, keepdim=True, unbiased=False)
    return (x - m) / torch.sqrt(v + eps)

def _scatter_add(tgt, idx, src, axis=0):
    return tgt.clone().index_add_(axis, idx, src)

def _segment_sum(src, seg, n):
    out = torch.zeros((n,) + src.shape[1:], dtype=src.dtype)
    return out.index_add_(0, seg, src)

def _pad(x, pw):
    flat = tuple((v for pair in reversed(pw) for v in pair))
    return torch.nn.functional.pad(x, flat)
kernel_name = 'gated_mix__softmax_full_mha__mixer_gmlp__prompt'

def setup_inputs():

    _w = lambda a: (lambda t: t.to(torch.bfloat16) if t.is_floating_point() else t)(torch.as_tensor(a))

    def _A_setup():
        B, S, D = (1, 2048, 640)
        return {'x': _w((lambda *s: torch.randn(*s, dtype=torch.bfloat16) * 0.05)(B, S, D)), 'wqkv': _w((lambda *s: torch.randn(*s, dtype=torch.bfloat16) * 0.8)(D, 3 * D)), 'wo': _w((lambda *s: torch.randn(*s, dtype=torch.bfloat16) * 0.1)(D, D))}
    _A_in = _A_setup()

    def _B_setup():
        B, S, D, F = (1, 2048, 640, 1728)
        Fh = F // 2
        return {'x': _w((lambda *s: torch.randn(*s, dtype=torch.bfloat16) * 0.05)(B, S, D)), 'w_in': _w((lambda *s: torch.randn(*s, dtype=torch.bfloat16) * 0.4)(D, 2 * Fh)), 'w_sp': _w(0.01 * (lambda *s: torch.randn(*s, dtype=torch.bfloat16) * 0.4)(S, S)), 'b_sp': _w(1.0 + 0.01 * (lambda *s: torch.randn(*s, dtype=torch.bfloat16) * 0.05)(S)), 'w_out': _w((lambda *s: torch.randn(*s, dtype=torch.bfloat16) * 0.05)(Fh, D))}
    _B_in = _B_setup()
    return {'A_x': _A_in['x'], 'A_wqkv': _A_in['wqkv'], 'A_wo': _A_in['wo'], 'B_x': _B_in['x'], 'B_w_in': _B_in['w_in'], 'B_w_sp': _B_in['w_sp'], 'B_b_sp': _B_in['b_sp'], 'B_w_out': _B_in['w_out'], 'gate_w': _w((lambda *s: torch.randn(*s, dtype=torch.bfloat16) * 0.05)(640) * 16.0)}

def reference(A_x, A_wqkv, A_wo, B_x, B_w_in, B_w_sp, B_b_sp, B_w_out, gate_w):

    def _A_ref(x, wqkv, wo):
        B, S, D = x.shape
        H = 32
        Dh = D // H
        qkv = (lambda x, *d: x.permute(*d))((x @ wqkv).reshape(B, S, 3, H, Dh), 2, 0, 3, 1, 4)
        q, k, v = (qkv[0], qkv[1], qkv[2])
        scale = Dh ** (-0.5)
        scores = torch.einsum('bhqd,bhkd->bhqk', q, k) * scale
        p = _softmax(scores, axis=-1)
        o = torch.einsum('bhqk,bhkd->bhqd', p, v)
        return (lambda x, *d: x.permute(*d))(o, 0, 2, 1, 3).reshape(B, S, D) @ wo

    def _B_ref(x, w_in, w_sp, b_sp, w_out):
        B, S, D = x.shape
        F = w_in.shape[-1]
        Fh = F // 2
        z = _gelu(torch.einsum('bsd,df->bsf', x, w_in))
        z1 = z[..., :Fh].clone()
        z2 = _layernorm(z[..., Fh:], axis=-1)
        g = torch.einsum('ts,bsf->btf', w_sp, z2) + b_sp[None, :, None]
        return torch.einsum('bsf,fd->bsd', z1 * g, w_out)
    x = A_x
    g = _sigmoid((x * gate_w).sum(-1, keepdims=True))
    a = _A_ref(x, A_wqkv, A_wo)
    b = _B_ref(x, B_w_in, B_w_sp, B_b_sp, B_w_out)
    return g * a + (1 - g) * b
```

```asm
; @launch kernel=k1_kernel grid=(256,1,1) block=(768,1,1) lds=163840
; @launch kernel=k2_kernel grid=(512,1,1) block=(512,1,1) lds=81920
.amdgcn_target "amdgcn-amd-amdhsa--gfx950"
    .text
    .globl k1_kernel
.p2align 8
    .type k1_kernel,@function
k1_kernel:
    s_cmp_ge_u32 s2, 256
    s_cbranch_scc1 k1_kernel_exit
    s_load_dwordx4 s[36:39], s[0:1], 0
    s_load_dwordx2 s[40:41], s[0:1], 16
    s_load_dwordx4 s[52:55], s[0:1], 32
    s_load_dwordx2 s[42:43], s[0:1], 56
    s_load_dwordx2 s[46:47], s[0:1], 88
    v_and_b32 v1, 63, v0
    v_lshrrev_b32 v2, 6, v0
    s_and_b32 s48, s2, 7
    v_readfirstlane_b32 s20, v2
    s_lshr_b32 s49, s2, 3
    s_and_b32 s23, s48, 1
    s_lshl_b32 s23, s23, 3
    s_and_b32 s50, s49, 7
    s_add_u32 s23, s23, s50
    s_lshr_b32 s24, s48, 1
    s_lshl_b32 s24, s24, 2
    s_lshr_b32 s50, s49, 3
    s_add_u32 s24, s24, s50
    s_lshr_b32 s50, s48, 1
    s_xor_b32 s50, s50, s48
    s_and_b32 s50, s50, 1
    s_mul_i32 s27, s50, 5
    s_mov_b32 s60, 0
    s_mov_b32 s61, 40960
    s_mov_b32 s62, 81920
    s_mov_b32 s63, 122880
    s_waitcnt lgkmcnt(0)
    s_cmp_lg_u32 s2, 0
    s_cbranch_scc1 k1_kernel_nozero
    s_cmp_lg_u32 s20, 0
    s_cbranch_scc1 k1_kernel_nozero
    s_add_u32 s16, s46, 30408704
    s_addc_u32 s17, s47, 0
    s_mov_b32 s18, 16384
    s_mov_b32 s19, 0x20000
    v_lshlrev_b32 v2, 4, v1
    v_mov_b32 v4, 0
    v_mov_b32 v5, 0
    v_mov_b32 v6, 0
    v_mov_b32 v7, 0
    s_movk_i32 s29, 0
    buffer_store_dwordx4 v[4:7], v2, s[16:19], s29 offen offset:0
    buffer_store_dwordx4 v[4:7], v2, s[16:19], s29 offen offset:1024
    buffer_store_dwordx4 v[4:7], v2, s[16:19], s29 offen offset:2048
    buffer_store_dwordx4 v[4:7], v2, s[16:19], s29 offen offset:3072
    s_movk_i32 s29, 4096
    buffer_store_dwordx4 v[4:7], v2, s[16:19], s29 offen offset:0
    buffer_store_dwordx4 v[4:7], v2, s[16:19], s29 offen offset:1024
    buffer_store_dwordx4 v[4:7], v2, s[16:19], s29 offen offset:2048
    buffer_store_dwordx4 v[4:7], v2, s[16:19], s29 offen offset:3072
    s_movk_i32 s29, 8192
    buffer_store_dwordx4 v[4:7], v2, s[16:19], s29 offen offset:0
    buffer_store_dwordx4 v[4:7], v2, s[16:19], s29 offen offset:1024
    buffer_store_dwordx4 v[4:7], v2, s[16:19], s29 offen offset:2048
    buffer_store_dwordx4 v[4:7], v2, s[16:19], s29 offen offset:3072
    s_movk_i32 s29, 12288
    buffer_store_dwordx4 v[4:7], v2, s[16:19], s29 offen offset:0
    buffer_store_dwordx4 v[4:7], v2, s[16:19], s29 offen offset:1024
    buffer_store_dwordx4 v[4:7], v2, s[16:19], s29 offen offset:2048
    buffer_store_dwordx4 v[4:7], v2, s[16:19], s29 offen offset:3072
k1_kernel_nozero:
    s_cmp_eq_u32 s24, 15
    s_cbranch_scc0 k1_kernel_work
    s_mul_i32 s29, s23, 12
    s_add_u32 s29, s29, s20
    s_cmp_ge_u32 s29, 182
    s_cbranch_scc1 k1_kernel_notile
    s_mul_i32 s30, s29, 2521
    s_lshr_b32 s30, s30, 16
    s_mul_i32 s31, s30, 26
    s_sub_u32 s31, s29, s31
    s_cmp_ge_u32 s31, 14
    s_cselect_b32 s32, 1, 0
    s_cselect_b32 s4, s40, s42
    s_cselect_b32 s5, s41, s43
    s_mov_b32 s6, 1105920
    s_cselect_b32 s6, 819200, s6
    s_mov_b32 s7, 0x20000
    s_add_u32 s16, s46, 31457280
    s_addc_u32 s17, s47, 0
    s_mov_b32 s18, 2236416
    s_mov_b32 s19, 0x20000
    s_mul_i32 s33, s30, 192
    s_sub_u32 s34, s31, 14
    s_mul_i32 s35, s29, 12288
    s_mov_b32 s56, 0x7fff0000
    v_add_u32 v2, 0, v1
    v_mul_u32_u24 v3, 5462, v2
    v_lshrrev_b32 v3, 16, v3
    v_mul_u32_u24 v4, 12, v3
    v_sub_u32 v4, v2, v4
    v_lshlrev_b32 v4, 4, v4
    v_add_u32 v4, s33, v4
    s_lshl_b32 s57, s31, 6
    v_add_u32 v5, s57, v3
    s_lshl_b32 s57, s34, 6
    v_add_u32 v6, s57, v3
    s_movk_i32 s57, 2731
    v_mul_lo_u32 v7, v6, s57
    v_lshrrev_b32 v7, 16, v7
    v_mul_u32_u24 v8, 24, v7
    v_sub_u32 v8, v6, v8
    v_mul_u32_u24 v7, 20, v7
    v_add_u32 v7, v7, v8
    s_cmp_eq_u32 s32, 1
    s_cselect_b64 vcc, -1, 0
    v_cndmask_b32 v5, v5, v7, vcc
    s_movk_i32 s57, 1280
    v_mul_lo_u32 v5, v5, s57
    v_add_u32 v5, v5, v4
    v_cmp_le_u32 s[58:59], 20, v8
    s_nop 1
    s_and_b64 s[58:59], s[58:59], vcc
    v_mov_b32 v9, s56
    s_nop 0
    v_cndmask_b32 v5, v5, v9, s[58:59]
    buffer_load_dwordx4 v[40:43], v5, s[4:7], 0 offen
    v_add_u32 v2, 64, v1
    v_mul_u32_u24 v3, 5462, v2
    v_lshrrev_b32 v3, 16, v3
    v_mul_u32_u24 v4, 12, v3
    v_sub_u32 v4, v2, v4
    v_lshlrev_b32 v4, 4, v4
    v_add_u32 v4, s33, v4
    s_lshl_b32 s57, s31, 6
    v_add_u32 v5, s57, v3
    s_lshl_b32 s57, s34, 6
    v_add_u32 v6, s57, v3
    s_movk_i32 s57, 2731
    v_mul_lo_u32 v7, v6, s57
    v_lshrrev_b32 v7, 16, v7
    v_mul_u32_u24 v8, 24, v7
    v_sub_u32 v8, v6, v8
    v_mul_u32_u24 v7, 20, v7
    v_add_u32 v7, v7, v8
    s_cmp_eq_u32 s32, 1
    s_cselect_b64 vcc, -1, 0
    v_cndmask_b32 v5, v5, v7, vcc
    s_movk_i32 s57, 1280
    v_mul_lo_u32 v5, v5, s57
    v_add_u32 v5, v5, v4
    v_cmp_le_u32 s[58:59], 20, v8
    s_nop 1
    s_and_b64 s[58:59], s[58:59], vcc
    v_mov_b32 v9, s56
    s_nop 0
    v_cndmask_b32 v5, v5, v9, s[58:59]
    buffer_load_dwordx4 v[44:47], v5, s[4:7], 0 offen
    v_add_u32 v2, 128, v1
    v_mul_u32_u24 v3, 5462, v2
    v_lshrrev_b32 v3, 16, v3
    v_mul_u32_u24 v4, 12, v3
    v_sub_u32 v4, v2, v4
    v_lshlrev_b32 v4, 4, v4
    v_add_u32 v4, s33, v4
    s_lshl_b32 s57, s31, 6
    v_add_u32 v5, s57, v3
    s_lshl_b32 s57, s34, 6
    v_add_u32 v6, s57, v3
    s_movk_i32 s57, 2731
    v_mul_lo_u32 v7, v6, s57
    v_lshrrev_b32 v7, 16, v7
    v_mul_u32_u24 v8, 24, v7
    v_sub_u32 v8, v6, v8
    v_mul_u32_u24 v7, 20, v7
    v_add_u32 v7, v7, v8
    s_cmp_eq_u32 s32, 1
    s_cselect_b64 vcc, -1, 0
    v_cndmask_b32 v5, v5, v7, vcc
    s_movk_i32 s57, 1280
    v_mul_lo_u32 v5, v5, s57
    v_add_u32 v5, v5, v4
    v_cmp_le_u32 s[58:59], 20, v8
    s_nop 1
    s_and_b64 s[58:59], s[58:59], vcc
    v_mov_b32 v9, s56
    s_nop 0
    v_cndmask_b32 v5, v5, v9, s[58:59]
    buffer_load_dwordx4 v[48:51], v5, s[4:7], 0 offen
    v_add_u32 v2, 192, v1
    v_mul_u32_u24 v3, 5462, v2
    v_lshrrev_b32 v3, 16, v3
    v_mul_u32_u24 v4, 12, v3
    v_sub_u32 v4, v2, v4
    v_lshlrev_b32 v4, 4, v4
    v_add_u32 v4, s33, v4
    s_lshl_b32 s57, s31, 6
    v_add_u32 v5, s57, v3
    s_lshl_b32 s57, s34, 6
    v_add_u32 v6, s57, v3
    s_movk_i32 s57, 2731
    v_mul_lo_u32 v7, v6, s57
    v_lshrrev_b32 v7, 16, v7
    v_mul_u32_u24 v8, 24, v7
    v_sub_u32 v8, v6, v8
    v_mul_u32_u24 v7, 20, v7
    v_add_u32 v7, v7, v8
    s_cmp_eq_u32 s32, 1
    s_cselect_b64 vcc, -1, 0
    v_cndmask_b32 v5, v5, v7, vcc
    s_movk_i32 s57, 1280
    v_mul_lo_u32 v5, v5, s57
    v_add_u32 v5, v5, v4
    v_cmp_le_u32 s[58:59], 20, v8
    s_nop 1
    s_and_b64 s[58:59], s[58:59], vcc
    v_mov_b32 v9, s56
    s_nop 0
    v_cndmask_b32 v5, v5, v9, s[58:59]
    buffer_load_dwordx4 v[52:55], v5, s[4:7], 0 offen
    v_add_u32 v2, 256, v1
    v_mul_u32_u24 v3, 5462, v2
    v_lshrrev_b32 v3, 16, v3
    v_mul_u32_u24 v4, 12, v3
    v_sub_u32 v4, v2, v4
    v_lshlrev_b32 v4, 4, v4
    v_add_u32 v4, s33, v4
    s_lshl_b32 s57, s31, 6
    v_add_u32 v5, s57, v3
    s_lshl_b32 s57, s34, 6
    v_add_u32 v6, s57, v3
    s_movk_i32 s57, 2731
    v_mul_lo_u32 v7, v6, s57
    v_lshrrev_b32 v7, 16, v7
    v_mul_u32_u24 v8, 24, v7
    v_sub_u32 v8, v6, v8
    v_mul_u32_u24 v7, 20, v7
    v_add_u32 v7, v7, v8
    s_cmp_eq_u32 s32, 1
    s_cselect_b64 vcc, -1, 0
    v_cndmask_b32 v5, v5, v7, vcc
    s_movk_i32 s57, 1280
    v_mul_lo_u32 v5, v5, s57
    v_add_u32 v5, v5, v4
    v_cmp_le_u32 s[58:59], 20, v8
    s_nop 1
    s_and_b64 s[58:59], s[58:59], vcc
    v_mov_b32 v9, s56
    s_nop 0
    v_cndmask_b32 v5, v5, v9, s[58:59]
    buffer_load_dwordx4 v[56:59], v5, s[4:7], 0 offen
    v_add_u32 v2, 320, v1
    v_mul_u32_u24 v3, 5462, v2
    v_lshrrev_b32 v3, 16, v3
    v_mul_u32_u24 v4, 12, v3
    v_sub_u32 v4, v2, v4
    v_lshlrev_b32 v4, 4, v4
    v_add_u32 v4, s33, v4
    s_lshl_b32 s57, s31, 6
    v_add_u32 v5, s57, v3
    s_lshl_b32 s57, s34, 6
    v_add_u32 v6, s57, v3
    s_movk_i32 s57, 2731
    v_mul_lo_u32 v7, v6, s57
    v_lshrrev_b32 v7, 16, v7
    v_mul_u32_u24 v8, 24, v7
    v_sub_u32 v8, v6, v8
    v_mul_u32_u24 v7, 20, v7
    v_add_u32 v7, v7, v8
    s_cmp_eq_u32 s32, 1
    s_cselect_b64 vcc, -1, 0
    v_cndmask_b32 v5, v5, v7, vcc
    s_movk_i32 s57, 1280
    v_mul_lo_u32 v5, v5, s57
    v_add_u32 v5, v5, v4
    v_cmp_le_u32 s[58:59], 20, v8
    s_nop 1
    s_and_b64 s[58:59], s[58:59], vcc
    v_mov_b32 v9, s56
    s_nop 0
    v_cndmask_b32 v5, v5, v9, s[58:59]
    buffer_load_dwordx4 v[60:63], v5, s[4:7], 0 offen
    v_add_u32 v2, 384, v1
    v_mul_u32_u24 v3, 5462, v2
    v_lshrrev_b32 v3, 16, v3
    v_mul_u32_u24 v4, 12, v3
    v_sub_u32 v4, v2, v4
    v_lshlrev_b32 v4, 4, v4
    v_add_u32 v4, s33, v4
    s_lshl_b32 s57, s31, 6
    v_add_u32 v5, s57, v3
    s_lshl_b32 s57, s34, 6
    v_add_u32 v6, s57, v3
    s_movk_i32 s57, 2731
    v_mul_lo_u32 v7, v6, s57
    v_lshrrev_b32 v7, 16, v7
    v_mul_u32_u24 v8, 24, v7
    v_sub_u32 v8, v6, v8
    v_mul_u32_u24 v7, 20, v7
    v_add_u32 v7, v7, v8
    s_cmp_eq_u32 s32, 1
    s_cselect_b64 vcc, -1, 0
    v_cndmask_b32 v5, v5, v7, vcc
    s_movk_i32 s57, 1280
    v_mul_lo_u32 v5, v5, s57
    v_add_u32 v5, v5, v4
    v_cmp_le_u32 s[58:59], 20, v8
    s_nop 1
    s_and_b64 s[58:59], s[58:59], vcc
    v_mov_b32 v9, s56
    s_nop 0
    v_cndmask_b32 v5, v5, v9, s[58:59]
    buffer_load_dwordx4 v[64:67], v5, s[4:7], 0 offen
    v_add_u32 v2, 448, v1
    v_mul_u32_u24 v3, 5462, v2
    v_lshrrev_b32 v3, 16, v3
    v_mul_u32_u24 v4, 12, v3
    v_sub_u32 v4, v2, v4
    v_lshlrev_b32 v4, 4, v4
    v_add_u32 v4, s33, v4
    s_lshl_b32 s57, s31, 6
    v_add_u32 v5, s57, v3
    s_lshl_b32 s57, s34, 6
    v_add_u32 v6, s57, v3
    s_movk_i32 s57, 2731
    v_mul_lo_u32 v7, v6, s57
    v_lshrrev_b32 v7, 16, v7
    v_mul_u32_u24 v8, 24, v7
    v_sub_u32 v8, v6, v8
    v_mul_u32_u24 v7, 20, v7
    v_add_u32 v7, v7, v8
    s_cmp_eq_u32 s32, 1
    s_cselect_b64 vcc, -1, 0
    v_cndmask_b32 v5, v5, v7, vcc
    s_movk_i32 s57, 1280
    v_mul_lo_u32 v5, v5, s57
    v_add_u32 v5, v5, v4
    v_cmp_le_u32 s[58:59], 20, v8
    s_nop 1
    s_and_b64 s[58:59], s[58:59], vcc
    v_mov_b32 v9, s56
    s_nop 0
    v_cndmask_b32 v5, v5, v9, s[58:59]
    buffer_load_dwordx4 v[68:71], v5, s[4:7], 0 offen
    v_add_u32 v2, 512, v1
    v_mul_u32_u24 v3, 5462, v2
    v_lshrrev_b32 v3, 16, v3
    v_mul_u32_u24 v4, 12, v3
    v_sub_u32 v4, v2, v4
    v_lshlrev_b32 v4, 4, v4
    v_add_u32 v4, s33, v4
    s_lshl_b32 s57, s31, 6
    v_add_u32 v5, s57, v3
    s_lshl_b32 s57, s34, 6
    v_add_u32 v6, s57, v3
    s_movk_i32 s57, 2731
    v_mul_lo_u32 v7, v6, s57
    v_lshrrev_b32 v7, 16, v7
    v_mul_u32_u24 v8, 24, v7
    v_sub_u32 v8, v6, v8
    v_mul_u32_u24 v7, 20, v7
    v_add_u32 v7, v7, v8
    s_cmp_eq_u32 s32, 1
    s_cselect_b64 vcc, -1, 0
    v_cndmask_b32 v5, v5, v7, vcc
    s_movk_i32 s57, 1280
    v_mul_lo_u32 v5, v5, s57
    v_add_u32 v5, v5, v4
    v_cmp_le_u32 s[58:59], 20, v8
    s_nop 1
    s_and_b64 s[58:59], s[58:59], vcc
    v_mov_b32 v9, s56
    s_nop 0
    v_cndmask_b32 v5, v5, v9, s[58:59]
    buffer_load_dwordx4 v[72:75], v5, s[4:7], 0 offen
    v_add_u32 v2, 576, v1
    v_mul_u32_u24 v3, 5462, v2
    v_lshrrev_b32 v3, 16, v3
    v_mul_u32_u24 v4, 12, v3
    v_sub_u32 v4, v2, v4
    v_lshlrev_b32 v4, 4, v4
    v_add_u32 v4, s33, v4
    s_lshl_b32 s57, s31, 6
    v_add_u32 v5, s57, v3
    s_lshl_b32 s57, s34, 6
    v_add_u32 v6, s57, v3
    s_movk_i32 s57, 2731
    v_mul_lo_u32 v7, v6, s57
    v_lshrrev_b32 v7, 16, v7
    v_mul_u32_u24 v8, 24, v7
    v_sub_u32 v8, v6, v8
    v_mul_u32_u24 v7, 20, v7
    v_add_u32 v7, v7, v8
    s_cmp_eq_u32 s32, 1
    s_cselect_b64 vcc, -1, 0
    v_cndmask_b32 v5, v5, v7, vcc
    s_movk_i32 s57, 1280
    v_mul_lo_u32 v5, v5, s57
    v_add_u32 v5, v5, v4
    v_cmp_le_u32 s[58:59], 20, v8
    s_nop 1
    s_and_b64 s[58:59], s[58:59], vcc
    v_mov_b32 v9, s56
    s_nop 0
    v_cndmask_b32 v5, v5, v9, s[58:59]
    buffer_load_dwordx4 v[76:79], v5, s[4:7], 0 offen
    v_add_u32 v2, 640, v1
    v_mul_u32_u24 v3, 5462, v2
    v_lshrrev_b32 v3, 16, v3
    v_mul_u32_u24 v4, 12, v3
    v_sub_u32 v4, v2, v4
    v_lshlrev_b32 v4, 4, v4
    v_add_u32 v4, s33, v4
    s_lshl_b32 s57, s31, 6
    v_add_u32 v5, s57, v3
    s_lshl_b32 s57, s34, 6
    v_add_u32 v6, s57, v3
    s_movk_i32 s57, 2731
    v_mul_lo_u32 v7, v6, s57
    v_lshrrev_b32 v7, 16, v7
    v_mul_u32_u24 v8, 24, v7
    v_sub_u32 v8, v6, v8
    v_mul_u32_u24 v7, 20, v7
    v_add_u32 v7, v7, v8
    s_cmp_eq_u32 s32, 1
    s_cselect_b64 vcc, -1, 0
    v_cndmask_b32 v5, v5, v7, vcc
    s_movk_i32 s57, 1280
    v_mul_lo_u32 v5, v5, s57
    v_add_u32 v5, v5, v4
    v_cmp_le_u32 s[58:59], 20, v8
    s_nop 1
    s_and_b64 s[58:59], s[58:59], vcc
    v_mov_b32 v9, s56
    s_nop 0
    v_cndmask_b32 v5, v5, v9, s[58:59]
    buffer_load_dwordx4 v[80:83], v5, s[4:7], 0 offen
    v_add_u32 v2, 704, v1
    v_mul_u32_u24 v3, 5462, v2
    v_lshrrev_b32 v3, 16, v3
    v_mul_u32_u24 v4, 12, v3
    v_sub_u32 v4, v2, v4
    v_lshlrev_b32 v4, 4, v4
    v_add_u32 v4, s33, v4
    s_lshl_b32 s57, s31, 6
    v_add_u32 v5, s57, v3
    s_lshl_b32 s57, s34, 6
    v_add_u32 v6, s57, v3
    s_movk_i32 s57, 2731
    v_mul_lo_u32 v7, v6, s57
    v_lshrrev_b32 v7, 16, v7
    v_mul_u32_u24 v8, 24, v7
    v_sub_u32 v8, v6, v8
    v_mul_u32_u24 v7, 20, v7
    v_add_u32 v7, v7, v8
    s_cmp_eq_u32 s32, 1
    s_cselect_b64 vcc, -1, 0
    v_cndmask_b32 v5, v5, v7, vcc
    s_movk_i32 s57, 1280
    v_mul_lo_u32 v5, v5, s57
    v_add_u32 v5, v5, v4
    v_cmp_le_u32 s[58:59], 20, v8
    s_nop 1
    s_and_b64 s[58:59], s[58:59], vcc
    v_mov_b32 v9, s56
    s_nop 0
    v_cndmask_b32 v5, v5, v9, s[58:59]
    buffer_load_dwordx4 v[84:87], v5, s[4:7], 0 offen
    v_lshlrev_b32 v2, 4, v1
    v_add_u32 v2, s35, v2
    s_waitcnt vmcnt(0)
    s_movk_i32 s57, 0
    buffer_store_dwordx4 v[40:43], v2, s[16:19], s57 offen
    s_movk_i32 s57, 1024
    buffer_store_dwordx4 v[44:47], v2, s[16:19], s57 offen
    s_movk_i32 s57, 2048
    buffer_store_dwordx4 v[48:51], v2, s[16:19], s57 offen
    s_movk_i32 s57, 3072
    buffer_store_dwordx4 v[52:55], v2, s[16:19], s57 offen
    s_movk_i32 s57, 4096
    buffer_store_dwordx4 v[56:59], v2, s[16:19], s57 offen
    s_movk_i32 s57, 5120
    buffer_store_dwordx4 v[60:63], v2, s[16:19], s57 offen
    s_movk_i32 s57, 6144
    buffer_store_dwordx4 v[64:67], v2, s[16:19], s57 offen
    s_movk_i32 s57, 7168
    buffer_store_dwordx4 v[68:71], v2, s[16:19], s57 offen
    s_movk_i32 s57, 8192
    buffer_store_dwordx4 v[72:75], v2, s[16:19], s57 offen
    s_movk_i32 s57, 9216
    buffer_store_dwordx4 v[76:79], v2, s[16:19], s57 offen
    s_movk_i32 s57, 10240
    buffer_store_dwordx4 v[80:83], v2, s[16:19], s57 offen
    s_movk_i32 s57, 11264
    buffer_store_dwordx4 v[84:87], v2, s[16:19], s57 offen
k1_kernel_notile:
    s_cmp_ge_u32 s20, 8
    s_cbranch_scc1 k1_kernel_exit
    s_load_dwordx2 s[34:35], s[0:1], 64
    s_waitcnt lgkmcnt(0)
    s_mov_b32 s8, s36
    s_mov_b32 s9, s37
    s_mov_b32 s10, 2621440
    s_mov_b32 s11, 0x20000
    s_mov_b32 s12, s34
    s_mov_b32 s13, s35
    s_mov_b32 s14, 1280
    s_mov_b32 s15, 0x20000
    s_add_u32 s16, s46, 29360128
    s_addc_u32 s17, s47, 0
    s_mov_b32 s18, 8192
    s_mov_b32 s19, 0x20000
    s_lshl_b32 s22, s23, 7
    s_lshl_b32 s29, s20, 4
    s_add_u32 s22, s22, s29
    v_lshrrev_b32 v2, 4, v1
    v_and_b32 v3, 15, v1
    v_mul_u32_u24 v3, 80, v3
    v_add_u32 v4, s22, v2
    s_movk_i32 s54, 1280
    v_mul_lo_u32 v5, v4, s54
    v_add_u32 v5, v5, v3
    buffer_load_dwordx4 v[12:15], v3, s[12:15], 0 offen offset:0
    buffer_load_dwordx4 v[16:19], v3, s[12:15], 0 offen offset:16
    buffer_load_dwordx4 v[20:23], v3, s[12:15], 0 offen offset:32
    buffer_load_dwordx4 v[24:27], v3, s[12:15], 0 offen offset:48
    buffer_load_dwordx4 v[28:31], v3, s[12:15], 0 offen offset:64
    buffer_load_dwordx4 v[32:35], v5, s[8:11], 0 offen offset:0
    buffer_load_dwordx4 v[36:39], v5, s[8:11], 0 offen offset:16
    buffer_load_dwordx4 v[40:43], v5, s[8:11], 0 offen offset:32
    buffer_load_dwordx4 v[44:47], v5, s[8:11], 0 offen offset:48
    buffer_load_dwordx4 v[48:51], v5, s[8:11], 0 offen offset:64
    v_add_u32 v5, 5120, v5
    buffer_load_dwordx4 v[52:55], v5, s[8:11], 0 offen offset:0
    buffer_load_dwordx4 v[56:59], v5, s[8:11], 0 offen offset:16
    buffer_load_dwordx4 v[60:63], v5, s[8:11], 0 offen offset:32
    buffer_load_dwordx4 v[64:67], v5, s[8:11], 0 offen offset:48
    buffer_load_dwordx4 v[68:71], v5, s[8:11], 0 offen offset:64
    v_add_u32 v5, 5120, v5
    buffer_load_dwordx4 v[72:75], v5, s[8:11], 0 offen offset:0
    buffer_load_dwordx4 v[76:79], v5, s[8:11], 0 offen offset:16
    buffer_load_dwordx4 v[80:83], v5, s[8:11], 0 offen offset:32
    buffer_load_dwordx4 v[84:87], v5, s[8:11], 0 offen offset:48
    buffer_load_dwordx4 v[88:91], v5, s[8:11], 0 offen offset:64
    v_add_u32 v5, 5120, v5
    buffer_load_dwordx4 v[92:95], v5, s[8:11], 0 offen offset:0
    buffer_load_dwordx4 v[96:99], v5, s[8:11], 0 offen offset:16
    buffer_load_dwordx4 v[100:103], v5, s[8:11], 0 offen offset:32
    buffer_load_dwordx4 v[104:107], v5, s[8:11], 0 offen offset:48
    buffer_load_dwordx4 v[108:111], v5, s[8:11], 0 offen offset:64
    v_add_u32 v5, 5120, v5
    s_waitcnt vmcnt(0)
    v_mov_b32 v8, 0
    v_dot2_f32_bf16 v8, v32, v12, v8
    v_dot2_f32_bf16 v8, v33, v13, v8
    v_dot2_f32_bf16 v8, v34, v14, v8
    v_dot2_f32_bf16 v8, v35, v15, v8
    v_dot2_f32_bf16 v8, v36, v16, v8
    v_dot2_f32_bf16 v8, v37, v17, v8
    v_dot2_f32_bf16 v8, v38, v18, v8
    v_dot2_f32_bf16 v8, v39, v19, v8
    v_dot2_f32_bf16 v8, v40, v20, v8
    v_dot2_f32_bf16 v8, v41, v21, v8
    v_dot2_f32_bf16 v8, v42, v22, v8
    v_dot2_f32_bf16 v8, v43, v23, v8
    v_dot2_f32_bf16 v8, v44, v24, v8
    v_dot2_f32_bf16 v8, v45, v25, v8
    v_dot2_f32_bf16 v8, v46, v26, v8
    v_dot2_f32_bf16 v8, v47, v27, v8
    v_dot2_f32_bf16 v8, v48, v28, v8
    v_dot2_f32_bf16 v8, v49, v29, v8
    v_dot2_f32_bf16 v8, v50, v30, v8
    v_dot2_f32_bf16 v8, v51, v31, v8
    v_mov_b32 v9, 0
    v_dot2_f32_bf16 v9, v52, v12, v9
    v_dot2_f32_bf16 v9, v53, v13, v9
    v_dot2_f32_bf16 v9, v54, v14, v9
    v_dot2_f32_bf16 v9, v55, v15, v9
    v_dot2_f32_bf16 v9, v56, v16, v9
    v_dot2_f32_bf16 v9, v57, v17, v9
    v_dot2_f32_bf16 v9, v58, v18, v9
    v_dot2_f32_bf16 v9, v59, v19, v9
    v_dot2_f32_bf16 v9, v60, v20, v9
    v_dot2_f32_bf16 v9, v61, v21, v9
    v_dot2_f32_bf16 v9, v62, v22, v9
    v_dot2_f32_bf16 v9, v63, v23, v9
    v_dot2_f32_bf16 v9, v64, v24, v9
    v_dot2_f32_bf16 v9, v65, v25, v9
    v_dot2_f32_bf16 v9, v66, v26, v9
    v_dot2_f32_bf16 v9, v67, v27, v9
    v_dot2_f32_bf16 v9, v68, v28, v9
    v_dot2_f32_bf16 v9, v69, v29, v9
    v_dot2_f32_bf16 v9, v70, v30, v9
    v_dot2_f32_bf16 v9, v71, v31, v9
    v_mov_b32 v10, 0
    v_dot2_f32_bf16 v10, v72, v12, v10
    v_dot2_f32_bf16 v10, v73, v13, v10
    v_dot2_f32_bf16 v10, v74, v14, v10
    v_dot2_f32_bf16 v10, v75, v15, v10
    v_dot2_f32_bf16 v10, v76, v16, v10
    v_dot2_f32_bf16 v10, v77, v17, v10
    v_dot2_f32_bf16 v10, v78, v18, v10
    v_dot2_f32_bf16 v10, v79, v19, v10
    v_dot2_f32_bf16 v10, v80, v20, v10
    v_dot2_f32_bf16 v10, v81, v21, v10
    v_dot2_f32_bf16 v10, v82, v22, v10
    v_dot2_f32_bf16 v10, v83, v23, v10
    v_dot2_f32_bf16 v10, v84, v24, v10
    v_dot2_f32_bf16 v10, v85, v25, v10
    v_dot2_f32_bf16 v10, v86, v26, v10
    v_dot2_f32_bf16 v10, v87, v27, v10
    v_dot2_f32_bf16 v10, v88, v28, v10
    v_dot2_f32_bf16 v10, v89, v29, v10
    v_dot2_f32_bf16 v10, v90, v30, v10
    v_dot2_f32_bf16 v10, v91, v31, v10
    v_mov_b32 v11, 0
    v_dot2_f32_bf16 v11, v92, v12, v11
    v_dot2_f32_bf16 v11, v93, v13, v11
    v_dot2_f32_bf16 v11, v94, v14, v11
    v_dot2_f32_bf16 v11, v95, v15, v11
    v_dot2_f32_bf16 v11, v96, v16, v11
    v_dot2_f32_bf16 v11, v97, v17, v11
    v_dot2_f32_bf16 v11, v98, v18, v11
    v_dot2_f32_bf16 v11, v99, v19, v11
    v_dot2_f32_bf16 v11, v100, v20, v11
    v_dot2_f32_bf16 v11, v101, v21, v11
    v_dot2_f32_bf16 v11, v102, v22, v11
    v_dot2_f32_bf16 v11, v103, v23, v11
    v_dot2_f32_bf16 v11, v104, v24, v11
    v_dot2_f32_bf16 v11, v105, v25, v11
    v_dot2_f32_bf16 v11, v106, v26, v11
    v_dot2_f32_bf16 v11, v107, v27, v11
    v_dot2_f32_bf16 v11, v108, v28, v11
    v_dot2_f32_bf16 v11, v109, v29, v11
    v_dot2_f32_bf16 v11, v110, v30, v11
    v_dot2_f32_bf16 v11, v111, v31, v11
    s_nop 3
    v_add_f32_dpp v8, v8, v8 row_ror:8 row_mask:0xf bank_mask:0xf
    v_add_f32_dpp v9, v9, v9 row_ror:8 row_mask:0xf bank_mask:0xf
    v_add_f32_dpp v10, v10, v10 row_ror:8 row_mask:0xf bank_mask:0xf
    v_add_f32_dpp v11, v11, v11 row_ror:8 row_mask:0xf bank_mask:0xf
    s_nop 1
    v_add_f32_dpp v8, v8, v8 row_ror:4 row_mask:0xf bank_mask:0xf
    v_add_f32_dpp v9, v9, v9 row_ror:4 row_mask:0xf bank_mask:0xf
    v_add_f32_dpp v10, v10, v10 row_ror:4 row_mask:0xf bank_mask:0xf
    v_add_f32_dpp v11, v11, v11 row_ror:4 row_mask:0xf bank_mask:0xf
    s_nop 1
    v_add_f32_dpp v8, v8, v8 row_ror:2 row_mask:0xf bank_mask:0xf
    v_add_f32_dpp v9, v9, v9 row_ror:2 row_mask:0xf bank_mask:0xf
    v_add_f32_dpp v10, v10, v10 row_ror:2 row_mask:0xf bank_mask:0xf
    v_add_f32_dpp v11, v11, v11 row_ror:2 row_mask:0xf bank_mask:0xf
    s_nop 1
    v_add_f32_dpp v8, v8, v8 row_ror:1 row_mask:0xf bank_mask:0xf
    v_add_f32_dpp v9, v9, v9 row_ror:1 row_mask:0xf bank_mask:0xf
    v_add_f32_dpp v10, v10, v10 row_ror:1 row_mask:0xf bank_mask:0xf
    v_add_f32_dpp v11, v11, v11 row_ror:1 row_mask:0xf bank_mask:0xf
    s_nop 1
    v_mul_f32 v8, 0xbfb8aa3b, v8
    v_mul_f32 v9, 0xbfb8aa3b, v9
    v_mul_f32 v10, 0xbfb8aa3b, v10
    v_mul_f32 v11, 0xbfb8aa3b, v11
    v_exp_f32 v8, v8
    v_exp_f32 v9, v9
    v_exp_f32 v10, v10
    v_exp_f32 v11, v11
    s_nop 0
    v_add_f32 v8, 1.0, v8
    v_add_f32 v9, 1.0, v9
    v_add_f32 v10, 1.0, v10
    v_add_f32 v11, 1.0, v11
    v_rcp_f32 v8, v8
    v_rcp_f32 v9, v9
    v_rcp_f32 v10, v10
    v_rcp_f32 v11, v11
    v_lshlrev_b32 v4, 2, v4
    v_and_b32 v3, 15, v1
    v_cmp_eq_u32 vcc, 0, v3
    s_and_saveexec_b64 s[52:53], vcc
    buffer_store_dword v8, v4, s[16:19], 0 offen offset:0
    buffer_store_dword v9, v4, s[16:19], 0 offen offset:16
    buffer_store_dword v10, v4, s[16:19], 0 offen offset:32
    buffer_store_dword v11, v4, s[16:19], 0 offen offset:48
    s_mov_b64 exec, s[52:53]
    s_branch k1_kernel_exit
k1_kernel_work:
    s_cmp_ge_u32 s20, 8
    s_cbranch_scc0 k1_kernel_cons
    s_sub_u32 s21, s20, 8
    s_mov_b32 s4, s36
    s_mov_b32 s5, s37
    s_mov_b32 s6, 2621440
    s_mov_b32 s7, 0x20000
    s_mov_b32 s8, s38
    s_mov_b32 s9, s39
    s_mov_b32 s10, 2457600
    s_mov_b32 s11, 0x20000
    s_mov_b32 s12, s52
    s_mov_b32 s13, s53
    s_mov_b32 s14, 2211840
    s_mov_b32 s15, 0x20000
    v_lshrrev_b32 v2, 3, v1
    v_and_b32 v3, 7, v1
    s_lshl_b32 s29, s23, 7
    s_lshl_b32 s30, s21, 5
    s_add_u32 s29, s29, s30
    v_add_u32 v4, s29, v2
    s_movk_i32 s30, 1280
    v_mul_lo_u32 v4, v4, s30
    v_lshrrev_b32 v5, 1, v2
    v_xor_b32 v6, v5, v3
    v_lshl_add_u32 v6, v6, 4, v4
    v_add_u32 v10, 0, v6
    v_or_b32 v6, 4, v5
    v_xor_b32 v6, v6, v3
    v_lshl_add_u32 v6, v6, 4, v4
    v_add_u32 v11, 9216, v6
    v_xor_b32 v6, v5, v3
    v_lshl_add_u32 v6, v6, 4, v4
    v_add_u32 v12, 18432, v6
    v_or_b32 v6, 4, v5
    v_xor_b32 v6, v6, v3
    v_lshl_add_u32 v6, v6, 4, v4
    v_add_u32 v13, 27648, v6
    v_and_b32 v5, 2, v2
    v_lshlrev_b32 v5, 1, v5
    v_xor_b32 v5, v5, v3
    v_lshlrev_b32 v5, 4, v5
    s_lshl_b32 s29, s21, 4
    v_add_u32 v4, s29, v2
    s_lshl_b32 s31, s24, 8
    s_lshl_b32 s32, s24, 7
    s_movk_i32 s30, 3840
    v_mul_lo_u32 v6, v4, s30
    v_add_u32 v6, v6, v5
    v_add_u32 v6, s31, v6
    v_add_u32 v14, 0, v6
    v_add_u32 v15, 29696, v6
    v_add_u32 v16, 128, v6
    v_add_u32 v17, 29824, v6
    s_movk_i32 s30, 3456
    v_mul_lo_u32 v6, v4, s30
    v_add_u32 v6, v6, v5
    v_add_u32 v6, s32, v6
    v_add_u32 v18, 1728, v6
    v_add_u32 v19, 28352, v6
    s_lshl_b32 s33, s21, 12
    s_lshl_b32 s34, s21, 11
    s_add_u32 s34, s34, 16384
    s_lshl_b32 s28, s27, 7
    s_mul_i32 s29, s27, 245760
    s_mul_i32 s30, s27, 221184
    s_add_u32 m0, s60, s33
    s_add_u32 s27, s27, 1
    buffer_load_dwordx4 v10, s[4:7], s28 offen offset:0 lds
    buffer_load_dwordx4 v11, s[4:7], s28 offen offset:1024 lds
    buffer_load_dwordx4 v12, s[4:7], s28 offen offset:2048 lds
    buffer_load_dwordx4 v13, s[4:7], s28 offen offset:3072 lds
    s_add_u32 m0, s60, s34
    s_nop 0
    buffer_load_dwordx4 v14, s[8:11], s29 offen offset:0 lds
    buffer_load_dwordx4 v15, s[8:11], s29 offen offset:1024 lds
    s_add_u32 m0, s60, s34
    s_add_u32 m0, m0, 8192
    s_nop 0
    buffer_load_dwordx4 v16, s[8:11], s29 offen offset:0 lds
    buffer_load_dwordx4 v17, s[8:11], s29 offen offset:1024 lds
    s_add_u32 m0, s60, s34
    s_add_u32 m0, m0, 16384
    s_nop 0
    buffer_load_dwordx4 v18, s[12:15], s30 offen offset:0 lds
    buffer_load_dwordx4 v19, s[12:15], s30 offen offset:1024 lds
    s_cmp_eq_u32 s27, 10
    s_cselect_b32 s27, 0, s27
    s_lshl_b32 s28, s27, 7
    s_mul_i32 s29, s27, 245760
    s_mul_i32 s30, s27, 221184
    s_add_u32 m0, s61, s33
    s_add_u32 s27, s27, 1
    buffer_load_dwordx4 v10, s[4:7], s28 offen offset:0 lds
    buffer_load_dwordx4 v11, s[4:7], s28 offen offset:1024 lds
    buffer_load_dwordx4 v12, s[4:7], s28 offen offset:2048 lds
    buffer_load_dwordx4 v13, s[4:7], s28 offen offset:3072 lds
    s_add_u32 m0, s61, s34
    s_nop 0
    buffer_load_dwordx4 v14, s[8:11], s29 offen offset:0 lds
    buffer_load_dwordx4 v15, s[8:11], s29 offen offset:1024 lds
    s_add_u32 m0, s61, s34
    s_add_u32 m0, m0, 8192
    s_nop 0
    buffer_load_dwordx4 v16, s[8:11], s29 offen offset:0 lds
    buffer_load_dwordx4 v17, s[8:11], s29 offen offset:1024 lds
    s_add_u32 m0, s61, s34
    s_add_u32 m0, m0, 16384
    s_nop 0
    buffer_load_dwordx4 v18, s[12:15], s30 offen offset:0 lds
    buffer_load_dwordx4 v19, s[12:15], s30 offen offset:1024 lds
    s_cmp_eq_u32 s27, 10
    s_cselect_b32 s27, 0, s27
    s_lshl_b32 s28, s27, 7
    s_mul_i32 s29, s27, 245760
    s_mul_i32 s30, s27, 221184
    s_add_u32 m0, s62, s33
    s_add_u32 s27, s27, 1
    buffer_load_dwordx4 v10, s[4:7], s28 offen offset:0 lds
    buffer_load_dwordx4 v11, s[4:7], s28 offen offset:1024 lds
    buffer_load_dwordx4 v12, s[4:7], s28 offen offset:2048 lds
    buffer_load_dwordx4 v13, s[4:7], s28 offen offset:3072 lds
    s_add_u32 m0, s62, s34
    s_nop 0
    buffer_load_dwordx4 v14, s[8:11], s29 offen offset:0 lds
    buffer_load_dwordx4 v15, s[8:11], s29 offen offset:1024 lds
    s_add_u32 m0, s62, s34
    s_add_u32 m0, m0, 8192
    s_nop 0
    buffer_load_dwordx4 v16, s[8:11], s29 offen offset:0 lds
    buffer_load_dwordx4 v17, s[8:11], s29 offen offset:1024 lds
    s_add_u32 m0, s62, s34
    s_add_u32 m0, m0, 16384
    s_nop 0
    buffer_load_dwordx4 v18, s[12:15], s30 offen offset:0 lds
    buffer_load_dwordx4 v19, s[12:15], s30 offen offset:1024 lds
    s_cmp_eq_u32 s27, 10
    s_cselect_b32 s27, 0, s27
    s_mul_i32 s35, s23, 15
    s_add_u32 s35, s35, s24
    s_mov_b32 s16, s54
    s_mov_b32 s17, s55
    s_mov_b32 s18, 8388608
    s_mov_b32 s19, 0x20000
    s_mul_i32 s56, s35, 35840
    s_mul_i32 s57, s21, 9216
    s_add_u32 s56, s56, s57
    v_lshlrev_b32 v30, 4, v1
    v_add_u32 v30, s56, v30
    s_mov_b32 s68, s42
    s_mov_b32 s69, s43
    s_mov_b32 s70, 1105920
    s_mov_b32 s71, 0x20000
    s_mul_i32 s56, s35, 4608
    s_mul_i32 s57, s21, 1152
    s_add_u32 s56, s56, s57
    v_lshlrev_b32 v31, 4, v1
    v_add_u32 v31, s56, v31
    s_mov_b32 s72, s40
    s_mov_b32 s73, s41
    s_mov_b32 s74, 819200
    s_mov_b32 s75, 0x20000
    s_mul_i32 s56, s35, 3584
    s_mul_i32 s57, s21, 896
    s_add_u32 s56, s56, s57
    v_lshlrev_b32 v32, 4, v1
    v_add_u32 v32, s56, v32
    s_lshl_b32 s56, s35, 2
    s_add_u32 s56, s56, s21
    s_mul_i32 s57, s56, 3456
    s_cmp_lt_u32 s56, 640
    s_cselect_b32 s57, s57, 0x7fff0000
    v_lshlrev_b32 v33, 4, v1
    v_add_u32 v33, s57, v33
    s_waitcnt vmcnt(10)
    s_barrier
    s_lshl_b32 s28, s27, 7
    s_mul_i32 s29, s27, 245760
    s_mul_i32 s30, s27, 221184
    s_add_u32 m0, s63, s33
    s_add_u32 s27, s27, 1
    buffer_load_dwordx4 v10, s[4:7], s28 offen offset:0 lds
    buffer_load_dwordx4 v11, s[4:7], s28 offen offset:1024 lds
    buffer_load_dwordx4 v12, s[4:7], s28 offen offset:2048 lds
    buffer_load_dwordx4 v13, s[4:7], s28 offen offset:3072 lds
    s_add_u32 m0, s63, s34
    s_nop 0
    buffer_load_dwordx4 v14, s[8:11], s29 offen offset:0 lds
    buffer_load_dwordx4 v15, s[8:11], s29 offen offset:1024 lds
    s_add_u32 m0, s63, s34
    s_add_u32 m0, m0, 8192
    s_nop 0
    buffer_load_dwordx4 v16, s[8:11], s29 offen offset:0 lds
    buffer_load_dwordx4 v17, s[8:11], s29 offen offset:1024 lds
    s_add_u32 m0, s63, s34
    s_add_u32 m0, m0, 16384
    s_nop 0
    buffer_load_dwordx4 v18, s[12:15], s30 offen offset:0 lds
    buffer_load_dwordx4 v19, s[12:15], s30 offen offset:1024 lds
    s_cmp_eq_u32 s27, 10
    s_cselect_b32 s27, 0, s27
    s_mov_b32 s64, s60
    s_mov_b32 s60, s61
    s_mov_b32 s61, s62
    s_mov_b32 s62, s63
    s_mov_b32 s63, s64
    s_waitcnt vmcnt(10)
    s_barrier
    s_lshl_b32 s28, s27, 7
    s_mul_i32 s29, s27, 245760
    s_mul_i32 s30, s27, 221184
    s_add_u32 m0, s63, s33
    s_add_u32 s27, s27, 1
    buffer_load_dwordx4 v10, s[4:7], s28 offen offset:0 lds
    buffer_load_dwordx4 v11, s[4:7], s28 offen offset:1024 lds
    buffer_load_dwordx4 v12, s[4:7], s28 offen offset:2048 lds
    buffer_load_dwordx4 v13, s[4:7], s28 offen offset:3072 lds
    s_add_u32 m0, s63, s34
    s_nop 0
    buffer_load_dwordx4 v14, s[8:11], s29 offen offset:0 lds
    buffer_load_dwordx4 v15, s[8:11], s29 offen offset:1024 lds
    s_add_u32 m0, s63, s34
    s_add_u32 m0, m0, 8192
    s_nop 0
    buffer_load_dwordx4 v16, s[8:11], s29 offen offset:0 lds
    buffer_load_dwordx4 v17, s[8:11], s29 offen offset:1024 lds
    s_add_u32 m0, s63, s34
    s_add_u32 m0, m0, 16384
    s_nop 0
    buffer_load_dwordx4 v18, s[12:15], s30 offen offset:0 lds
    buffer_load_dwordx4 v19, s[12:15], s30 offen offset:1024 lds
    s_cmp_eq_u32 s27, 10
    s_cselect_b32 s27, 0, s27
    s_mov_b32 s64, s60
    s_mov_b32 s60, s61
    s_mov_b32 s61, s62
    s_mov_b32 s62, s63
    s_mov_b32 s63, s64
    s_waitcnt vmcnt(10)
    s_barrier
    s_lshl_b32 s28, s27, 7
    s_mul_i32 s29, s27, 245760
    s_mul_i32 s30, s27, 221184
    s_add_u32 m0, s63, s33
    s_add_u32 s27, s27, 1
    buffer_load_dwordx4 v10, s[4:7], s28 offen offset:0 lds
    buffer_load_dwordx4 v11, s[4:7], s28 offen offset:1024 lds
    buffer_load_dwordx4 v12, s[4:7], s28 offen offset:2048 lds
    buffer_load_dwordx4 v13, s[4:7], s28 offen offset:3072 lds
    s_add_u32 m0, s63, s34
    s_nop 0
    buffer_load_dwordx4 v14, s[8:11], s29 offen offset:0 lds
    buffer_load_dwordx4 v15, s[8:11], s29 offen offset:1024 lds
    s_add_u32 m0, s63, s34
    s_add_u32 m0, m0, 8192
    s_nop 0
    buffer_load_dwordx4 v16, s[8:11], s29 offen offset:0 lds
    buffer_load_dwordx4 v17, s[8:11], s29 offen offset:1024 lds
    s_add_u32 m0, s63, s34
    s_add_u32 m0, m0, 16384
    s_nop 0
    buffer_load_dwordx4 v18, s[12:15], s30 offen offset:0 lds
    buffer_load_dwordx4 v19, s[12:15], s30 offen offset:1024 lds
    s_cmp_eq_u32 s27, 10
    s_cselect_b32 s27, 0, s27
    s_mov_b32 s64, s60
    s_mov_b32 s60, s61
    s_mov_b32 s61, s62
    s_mov_b32 s62, s63
    s_mov_b32 s63, s64
    s_waitcnt vmcnt(10)
    s_barrier
    s_lshl_b32 s28, s27, 7
    s_mul_i32 s29, s27, 245760
    s_mul_i32 s30, s27, 221184
    s_add_u32 m0, s63, s33
    s_add_u32 s27, s27, 1
    buffer_load_dwordx4 v10, s[4:7], s28 offen offset:0 lds
    buffer_load_dwordx4 v11, s[4:7], s28 offen offset:1024 lds
    buffer_load_dwordx4 v12, s[4:7], s28 offen offset:2048 lds
    buffer_load_dwordx4 v13, s[4:7], s28 offen offset:3072 lds
    s_add_u32 m0, s63, s34
    s_nop 0
    buffer_load_dwordx4 v14, s[8:11], s29 offen offset:0 lds
    buffer_load_dwordx4 v15, s[8:11], s29 offen offset:1024 lds
    s_add_u32 m0, s63, s34
    s_add_u32 m0, m0, 8192
    s_nop 0
    buffer_load_dwordx4 v16, s[8:11], s29 offen offset:0 lds
    buffer_load_dwordx4 v17, s[8:11], s29 offen offset:1024 lds
    s_add_u32 m0, s63, s34
    s_add_u32 m0, m0, 16384
    s_nop 0
    buffer_load_dwordx4 v18, s[12:15], s30 offen offset:0 lds
    buffer_load_dwordx4 v19, s[12:15], s30 offen offset:1024 lds
    s_cmp_eq_u32 s27, 10
    s_cselect_b32 s27, 0, s27
    s_mov_b32 s64, s60
    s_mov_b32 s60, s61
    s_mov_b32 s61, s62
    s_mov_b32 s62, s63
    s_mov_b32 s63, s64
    s_waitcnt vmcnt(10)
    s_barrier
    s_lshl_b32 s28, s27, 7
    s_mul_i32 s29, s27, 245760
    s_mul_i32 s30, s27, 221184
    s_add_u32 m0, s63, s33
    s_add_u32 s27, s27, 1
    buffer_load_dwordx4 v10, s[4:7], s28 offen offset:0 lds
    buffer_load_dwordx4 v11, s[4:7], s28 offen offset:1024 lds
    buffer_load_dwordx4 v12, s[4:7], s28 offen offset:2048 lds
    buffer_load_dwordx4 v13, s[4:7], s28 offen offset:3072 lds
    s_add_u32 m0, s63, s34
    s_nop 0
    buffer_load_dwordx4 v14, s[8:11], s29 offen offset:0 lds
    buffer_load_dwordx4 v15, s[8:11], s29 offen offset:1024 lds
    s_add_u32 m0, s63, s34
    s_add_u32 m0, m0, 8192
    s_nop 0
    buffer_load_dwordx4 v16, s[8:11], s29 offen offset:0 lds
    buffer_load_dwordx4 v17, s[8:11], s29 offen offset:1024 lds
    s_add_u32 m0, s63, s34
    s_add_u32 m0, m0, 16384
    s_nop 0
    buffer_load_dwordx4 v18, s[12:15], s30 offen offset:0 lds
    buffer_load_dwordx4 v19, s[12:15], s30 offen offset:1024 lds
    s_cmp_eq_u32 s27, 10
    s_cselect_b32 s27, 0, s27
    s_mov_b32 s64, s60
    s_mov_b32 s60, s61
    s_mov_b32 s61, s62
    s_mov_b32 s62, s63
    s_mov_b32 s63, s64
    s_waitcnt vmcnt(10)
    s_barrier
    s_lshl_b32 s28, s27, 7
    s_mul_i32 s29, s27, 245760
    s_mul_i32 s30, s27, 221184
    s_add_u32 m0, s63, s33
    s_add_u32 s27, s27, 1
    buffer_load_dwordx4 v10, s[4:7], s28 offen offset:0 lds
    buffer_load_dwordx4 v11, s[4:7], s28 offen offset:1024 lds
    buffer_load_dwordx4 v12, s[4:7], s28 offen offset:2048 lds
    buffer_load_dwordx4 v13, s[4:7], s28 offen offset:3072 lds
    s_add_u32 m0, s63, s34
    s_nop 0
    buffer_load_dwordx4 v14, s[8:11], s29 offen offset:0 lds
    buffer_load_dwordx4 v15, s[8:11], s29 offen offset:1024 lds
    s_add_u32 m0, s63, s34
    s_add_u32 m0, m0, 8192
    s_nop 0
    buffer_load_dwordx4 v16, s[8:11], s29 offen offset:0 lds
    buffer_load_dwordx4 v17, s[8:11], s29 offen offset:1024 lds
    s_add_u32 m0, s63, s34
    s_add_u32 m0, m0, 16384
    s_nop 0
    buffer_load_dwordx4 v18, s[12:15], s30 offen offset:0 lds
    buffer_load_dwordx4 v19, s[12:15], s30 offen offset:1024 lds
    s_cmp_eq_u32 s27, 10
    s_cselect_b32 s27, 0, s27
    s_mov_b32 s64, s60
    s_mov_b32 s60, s61
    s_mov_b32 s61, s62
    s_mov_b32 s62, s63
    s_mov_b32 s63, s64
    s_waitcnt vmcnt(10)
    s_barrier
    s_lshl_b32 s28, s27, 7
    s_mul_i32 s29, s27, 245760
    s_mul_i32 s30, s27, 221184
    s_add_u32 m0, s63, s33
    s_add_u32 s27, s27, 1
    buffer_load_dwordx4 v10, s[4:7], s28 offen offset:0 lds
    buffer_load_dwordx4 v11, s[4:7], s28 offen offset:1024 lds
    buffer_load_dwordx4 v12, s[4:7], s28 offen offset:2048 lds
    buffer_load_dwordx4 v13, s[4:7], s28 offen offset:3072 lds
    s_add_u32 m0, s63, s34
    s_nop 0
    buffer_load_dwordx4 v14, s[8:11], s29 offen offset:0 lds
    buffer_load_dwordx4 v15, s[8:11], s29 offen offset:1024 lds
    s_add_u32 m0, s63, s34
    s_add_u32 m0, m0, 8192
    s_nop 0
    buffer_load_dwordx4 v16, s[8:11], s29 offen offset:0 lds
    buffer_load_dwordx4 v17, s[8:11], s29 offen offset:1024 lds
    s_add_u32 m0, s63, s34
    s_add_u32 m0, m0, 16384
    s_nop 0
    buffer_load_dwordx4 v18, s[12:15], s30 offen offset:0 lds
    buffer_load_dwordx4 v19, s[12:15], s30 offen offset:1024 lds
    s_cmp_eq_u32 s27, 10
    s_cselect_b32 s27, 0, s27
    s_mov_b32 s64, s60
    s_mov_b32 s60, s61
    s_mov_b32 s61, s62
    s_mov_b32 s62, s63
    s_mov_b32 s63, s64
    s_waitcnt vmcnt(10)
    s_barrier
    buffer_load_dwordx4 v[40:43], v33, s[12:15], 0 offen offset:0
    buffer_load_dwordx4 v[44:47], v33, s[12:15], 0 offen offset:1024
    s_mov_b32 s64, s60
    s_mov_b32 s60, s61
    s_mov_b32 s61, s62
    s_mov_b32 s62, s63
    s_mov_b32 s63, s64
    s_waitcnt vmcnt(2)
    s_barrier
    s_mov_b32 s56, 0
    buffer_load_dwordx4 v[40:43], v30, s[16:19], s56 offen
    s_mov_b32 s56, 1024
    buffer_load_dwordx4 v[44:47], v30, s[16:19], s56 offen
    s_mov_b32 s56, 2048
    buffer_load_dwordx4 v[40:43], v30, s[16:19], s56 offen
    s_mov_b32 s56, 3072
    buffer_load_dwordx4 v[44:47], v30, s[16:19], s56 offen
    s_mov_b32 s56, 4096
    buffer_load_dwordx4 v[40:43], v30, s[16:19], s56 offen
    s_mov_b32 s64, s60
    s_mov_b32 s60, s61
    s_mov_b32 s61, s62
    s_mov_b32 s62, s63
    s_mov_b32 s63, s64
    s_waitcnt vmcnt(7)
    s_barrier
    s_mov_b32 s56, 5120
    buffer_load_dwordx4 v[40:43], v30, s[16:19], s56 offen
    s_mov_b32 s56, 6144
    buffer_load_dwordx4 v[44:47], v30, s[16:19], s56 offen
    s_mov_b32 s56, 7168
    buffer_load_dwordx4 v[40:43], v30, s[16:19], s56 offen
    s_mov_b32 s56, 8192
    buffer_load_dwordx4 v[44:47], v30, s[16:19], s56 offen
    s_mov_b32 s64, s60
    s_mov_b32 s60, s61
    s_mov_b32 s61, s62
    s_mov_b32 s62, s63
    s_mov_b32 s63, s64
    s_branch k1_kernel_exit
k1_kernel_cons:
    s_and_b32 s21, s20, 3
    s_lshr_b32 s22, s20, 2
    v_and_b32 v2, 31, v1
    s_lshl_b32 s29, s21, 5
    v_add_u32 v2, s29, v2
    v_lshlrev_b32 v2, 7, v2
    v_lshrrev_b32 v3, 5, v1
    v_bfe_u32 v4, v1, 1, 3
    v_or_b32 v5, 0, v3
    v_xor_b32 v5, v5, v4
    v_lshl_add_u32 v10, v5, 4, v2
    v_or_b32 v5, 2, v3
    v_xor_b32 v5, v5, v4
    v_lshl_add_u32 v11, v5, 4, v2
    v_or_b32 v5, 4, v3
    v_xor_b32 v5, v5, v4
    v_lshl_add_u32 v12, v5, 4, v2
    v_or_b32 v5, 6, v3
    v_xor_b32 v5, v5, v4
    v_lshl_add_u32 v13, v5, 4, v2
    v_lshrrev_b32 v2, 5, v1
    v_bfe_u32 v3, v1, 2, 2
    v_lshl_add_u32 v4, v2, 3, v3
    v_lshlrev_b32 v4, 7, v4
    v_bfe_u32 v5, v1, 4, 1
    v_lshl_add_u32 v4, v5, 5, v4
    v_and_b32 v5, 1, v1
    v_lshl_add_u32 v4, v5, 4, v4
    v_bfe_u32 v5, v1, 1, 1
    v_lshl_add_u32 v4, v5, 3, v4
    v_add_u32 v4, 16384, v4
    v_lshrrev_b32 v3, 1, v3
    s_lshl_b32 s29, s22, 13
    v_xor_b32 v5, 0, v3
    v_lshl_add_u32 v5, v5, 6, v4
    v_add_u32 v14, s29, v5
    v_xor_b32 v5, 1, v3
    v_lshl_add_u32 v5, v5, 6, v4
    v_add_u32 v15, s29, v5
    v_xor_b32 v5, s22, v3
    v_lshl_add_u32 v5, v5, 6, v4
    v_add_u32 v16, 16384, v5
    v_mov_b32 v60, 0
    v_mov_b32 v61, 0
    v_mov_b32 v62, 0
    v_mov_b32 v63, 0
    v_mov_b32 v64, 0
    v_mov_b32 v65, 0
    v_mov_b32 v66, 0
    v_mov_b32 v67, 0
    v_mov_b32 v68, 0
    v_mov_b32 v69, 0
    v_mov_b32 v70, 0
    v_mov_b32 v71, 0
    v_mov_b32 v72, 0
    v_mov_b32 v73, 0
    v_mov_b32 v74, 0
    v_mov_b32 v75, 0
    v_mov_b32 v76, 0
    v_mov_b32 v77, 0
    v_mov_b32 v78, 0
    v_mov_b32 v79, 0
    v_mov_b32 v80, 0
    v_mov_b32 v81, 0
    v_mov_b32 v82, 0
    v_mov_b32 v83, 0
    v_mov_b32 v84, 0
    v_mov_b32 v85, 0
    v_mov_b32 v86, 0
    v_mov_b32 v87, 0
    v_mov_b32 v88, 0
    v_mov_b32 v89, 0
    v_mov_b32 v90, 0
    v_mov_b32 v91, 0
    v_mov_b32 v92, 0
    v_mov_b32 v93, 0
    v_mov_b32 v94, 0
    v_mov_b32 v95, 0
    v_mov_b32 v96, 0
    v_mov_b32 v97, 0
    v_mov_b32 v98, 0
    v_mov_b32 v99, 0
    v_mov_b32 v100, 0
    v_mov_b32 v101, 0
    v_mov_b32 v102, 0
    v_mov_b32 v103, 0
    v_mov_b32 v104, 0
    v_mov_b32 v105, 0
    v_mov_b32 v106, 0
    v_mov_b32 v107, 0
    s_mov_b32 s35, 10
    s_barrier
    v_add_u32 v18, s60, v10
    v_add_u32 v19, s60, v11
    v_add_u32 v20, s60, v12
    v_add_u32 v21, s60, v13
    v_add_u32 v22, s60, v14
    v_add_u32 v23, s60, v15
    v_add_u32 v24, s60, v16
    ds_read_b128 v[28:31], v18
    ds_read_b64_tr_b16 v[32:33], v22 offset:0
    ds_read_b64_tr_b16 v[34:35], v22 offset:512
    ds_read_b64_tr_b16 v[36:37], v23 offset:0
    ds_read_b64_tr_b16 v[38:39], v23 offset:512
    ds_read_b64_tr_b16 v[40:41], v24 offset:0
    ds_read_b64_tr_b16 v[42:43], v24 offset:512
.p2align 6
k1_kernel_loop:
    ds_read_b128 v[44:47], v19
    ds_read_b64_tr_b16 v[48:49], v22 offset:2048
    ds_read_b64_tr_b16 v[50:51], v22 offset:2560
    ds_read_b64_tr_b16 v[52:53], v23 offset:2048
    ds_read_b64_tr_b16 v[54:55], v23 offset:2560
    ds_read_b64_tr_b16 v[56:57], v24 offset:2048
    ds_read_b64_tr_b16 v[58:59], v24 offset:2560
    s_waitcnt lgkmcnt(7)
    v_mfma_f32_32x32x16_bf16 v[60:75], v[32:35], v[28:31], v[60:75]
    v_mfma_f32_32x32x16_bf16 v[76:91], v[36:39], v[28:31], v[76:91]
    v_mfma_f32_32x32x16_bf16 v[92:107], v[40:43], v[28:31], v[92:107]
    ds_read_b128 v[28:31], v20
    ds_read_b64_tr_b16 v[32:33], v22 offset:4096
    ds_read_b64_tr_b16 v[34:35], v22 offset:4608
    ds_read_b64_tr_b16 v[36:37], v23 offset:4096
    ds_read_b64_tr_b16 v[38:39], v23 offset:4608
    ds_read_b64_tr_b16 v[40:41], v24 offset:4096
    ds_read_b64_tr_b16 v[42:43], v24 offset:4608
    s_waitcnt lgkmcnt(7)
    v_mfma_f32_32x32x16_bf16 v[60:75], v[48:51], v[44:47], v[60:75]
    v_mfma_f32_32x32x16_bf16 v[76:91], v[52:55], v[44:47], v[76:91]
    v_mfma_f32_32x32x16_bf16 v[92:107], v[56:59], v[44:47], v[92:107]
    ds_read_b128 v[44:47], v21
    ds_read_b64_tr_b16 v[48:49], v22 offset:6144
    ds_read_b64_tr_b16 v[50:51], v22 offset:6656
    ds_read_b64_tr_b16 v[52:53], v23 offset:6144
    ds_read_b64_tr_b16 v[54:55], v23 offset:6656
    ds_read_b64_tr_b16 v[56:57], v24 offset:6144
    ds_read_b64_tr_b16 v[58:59], v24 offset:6656
    s_waitcnt lgkmcnt(7)
    v_mfma_f32_32x32x16_bf16 v[60:75], v[32:35], v[28:31], v[60:75]
    v_mfma_f32_32x32x16_bf16 v[76:91], v[36:39], v[28:31], v[76:91]
    v_mfma_f32_32x32x16_bf16 v[92:107], v[40:43], v[28:31], v[92:107]
    s_sub_u32 s35, s35, 1
    s_cmp_eq_u32 s35, 0
    s_cbranch_scc1 k1_kernel_last
    s_mov_b32 s64, s60
    s_mov_b32 s60, s61
    s_mov_b32 s61, s62
    s_mov_b32 s62, s63
    s_mov_b32 s63, s64
    v_add_u32 v18, s60, v10
    v_add_u32 v19, s60, v11
    v_add_u32 v20, s60, v12
    v_add_u32 v21, s60, v13
    v_add_u32 v22, s60, v14
    v_add_u32 v23, s60, v15
    v_add_u32 v24, s60, v16
    ds_read_b128 v[28:31], v18
    ds_read_b64_tr_b16 v[32:33], v22 offset:0
    ds_read_b64_tr_b16 v[34:35], v22 offset:512
    ds_read_b64_tr_b16 v[36:37], v23 offset:0
    ds_read_b64_tr_b16 v[38:39], v23 offset:512
    ds_read_b64_tr_b16 v[40:41], v24 offset:0
    ds_read_b64_tr_b16 v[42:43], v24 offset:512
    s_waitcnt lgkmcnt(7)
    v_mfma_f32_32x32x16_bf16 v[60:75], v[48:51], v[44:47], v[60:75]
    v_mfma_f32_32x32x16_bf16 v[76:91], v[52:55], v[44:47], v[76:91]
    v_mfma_f32_32x32x16_bf16 v[92:107], v[56:59], v[44:47], v[92:107]
    s_barrier
    s_branch k1_kernel_loop
k1_kernel_last:
    s_waitcnt lgkmcnt(0)
    v_mfma_f32_32x32x16_bf16 v[60:75], v[48:51], v[44:47], v[60:75]
    v_mfma_f32_32x32x16_bf16 v[76:91], v[52:55], v[44:47], v[76:91]
    v_mfma_f32_32x32x16_bf16 v[92:107], v[56:59], v[44:47], v[92:107]
    s_nop 15
    v_and_b32 v2, 31, v1
    v_lshrrev_b32 v3, 5, v1
    s_add_u32 s16, s46, 13107200
    s_addc_u32 s17, s47, 0
    s_mov_b32 s18, 3538944
    s_mov_b32 s19, 0x20000
    s_lshl_b32 s53, s23, 7
    s_lshl_b32 s55, s21, 5
    s_add_u32 s53, s53, s55
    v_add_u32 v4, s53, v2
    s_movk_i32 s54, 1728
    v_mul_lo_u32 v4, v4, s54
    v_lshl_add_u32 v4, v3, 4, v4
    s_lshl_b32 s53, s24, 7
    s_lshl_b32 s55, s22, 6
    s_add_u32 s53, s53, s55
    v_add_u32 v4, s53, v4
    s_lshl_b32 s53, s24, 1
    s_add_u32 s53, s53, s22
    s_cmp_ge_u32 s53, 27
    s_cbranch_scc1 k1_kernel_zskip_1
    v_mov_b32 v28, 0xbdd2d3e8
    v_mov_b32 v29, 0xbdd2d3e8
    v_mov_b32 v30, 0xc0135761
    v_mov_b32 v31, 0xc0135761
    v_mov_b32 v32, 1.0
    v_mov_b32 v33, 1.0
    v_pk_mul_f32 v[44:45], v[92:93], v[92:93]
    v_pk_mul_f32 v[46:47], v[94:95], v[94:95]
    v_pk_mul_f32 v[48:49], v[96:97], v[96:97]
    v_pk_mul_f32 v[50:51], v[98:99], v[98:99]
    v_pk_mul_f32 v[52:53], v[100:101], v[100:101]
    v_pk_mul_f32 v[54:55], v[102:103], v[102:103]
    v_pk_mul_f32 v[56:57], v[104:105], v[104:105]
    v_pk_mul_f32 v[58:59], v[106:107], v[106:107]
    v_pk_fma_f32 v[44:45], v[44:45], v[28:29], v[30:31]
    v_pk_fma_f32 v[46:47], v[46:47], v[28:29], v[30:31]
    v_pk_fma_f32 v[48:49], v[48:49], v[28:29], v[30:31]
    v_pk_fma_f32 v[50:51], v[50:51], v[28:29], v[30:31]
    v_pk_fma_f32 v[52:53], v[52:53], v[28:29], v[30:31]
    v_pk_fma_f32 v[54:55], v[54:55], v[28:29], v[30:31]
    v_pk_fma_f32 v[56:57], v[56:57], v[28:29], v[30:31]
    v_pk_fma_f32 v[58:59], v[58:59], v[28:29], v[30:31]
    v_pk_mul_f32 v[44:45], v[44:45], v[92:93]
    v_pk_mul_f32 v[46:47], v[46:47], v[94:95]
    v_pk_mul_f32 v[48:49], v[48:49], v[96:97]
    v_pk_mul_f32 v[50:51], v[50:51], v[98:99]
    v_pk_mul_f32 v[52:53], v[52:53], v[100:101]
    v_pk_mul_f32 v[54:55], v[54:55], v[102:103]
    v_pk_mul_f32 v[56:57], v[56:57], v[104:105]
    v_pk_mul_f32 v[58:59], v[58:59], v[106:107]
    v_exp_f32 v44, v44
    v_exp_f32 v45, v45
    v_exp_f32 v46, v46
    v_exp_f32 v47, v47
    v_exp_f32 v48, v48
    v_exp_f32 v49, v49
    v_exp_f32 v50, v50
    v_exp_f32 v51, v51
    v_exp_f32 v52, v52
    v_exp_f32 v53, v53
    v_exp_f32 v54, v54
    v_exp_f32 v55, v55
    v_exp_f32 v56, v56
    v_exp_f32 v57, v57
    v_exp_f32 v58, v58
    v_exp_f32 v59, v59
    s_nop 0
    v_pk_add_f32 v[44:45], v[44:45], v[32:33]
    v_pk_add_f32 v[46:47], v[46:47], v[32:33]
    v_pk_add_f32 v[48:49], v[48:49], v[32:33]
    v_pk_add_f32 v[50:51], v[50:51], v[32:33]
    v_pk_add_f32 v[52:53], v[52:53], v[32:33]
    v_pk_add_f32 v[54:55], v[54:55], v[32:33]
    v_pk_add_f32 v[56:57], v[56:57], v[32:33]
    v_pk_add_f32 v[58:59], v[58:59], v[32:33]
    v_rcp_f32 v44, v44
    v_rcp_f32 v45, v45
    v_rcp_f32 v46, v46
    v_rcp_f32 v47, v47
    v_rcp_f32 v48, v48
    v_rcp_f32 v49, v49
    v_rcp_f32 v50, v50
    v_rcp_f32 v51, v51
    v_rcp_f32 v52, v52
    v_rcp_f32 v53, v53
    v_rcp_f32 v54, v54
    v_rcp_f32 v55, v55
    v_rcp_f32 v56, v56
    v_rcp_f32 v57, v57
    v_rcp_f32 v58, v58
    v_rcp_f32 v59, v59
    s_nop 0
    v_pk_mul_f32 v[92:93], v[92:93], v[44:45]
    v_pk_mul_f32 v[94:95], v[94:95], v[46:47]
    v_pk_mul_f32 v[96:97], v[96:97], v[48:49]
    v_pk_mul_f32 v[98:99], v[98:99], v[50:51]
    v_pk_mul_f32 v[100:101], v[100:101], v[52:53]
    v_pk_mul_f32 v[102:103], v[102:103], v[54:55]
    v_pk_mul_f32 v[104:105], v[104:105], v[56:57]
    v_pk_mul_f32 v[106:107], v[106:107], v[58:59]
    v_cvt_pk_bf16_f32 v36, v92, v93
    v_cvt_pk_bf16_f32 v37, v94, v95
    v_cvt_pk_bf16_f32 v38, v96, v97
    v_cvt_pk_bf16_f32 v39, v98, v99
    v_cvt_pk_bf16_f32 v40, v100, v101
    v_cvt_pk_bf16_f32 v41, v102, v103
    v_cvt_pk_bf16_f32 v42, v104, v105
    v_cvt_pk_bf16_f32 v43, v106, v107
    s_lshl_b32 s55, s20, 11
    s_add_u32 s55, s55, 81920
    v_lshlrev_b32 v5, 6, v2
    v_lshl_add_u32 v5, v3, 4, v5
    v_add_u32 v5, s55, v5
    ds_write_b128 v5, v[36:39] offset:0
    ds_write_b128 v5, v[40:43] offset:32
    v_lshlrev_b32 v6, 4, v1
    v_add_u32 v6, s55, v6
    s_waitcnt lgkmcnt(0)
    ds_read_b128 v[36:39], v6
    ds_read_b128 v[40:43], v6 offset:1024
    s_lshl_b32 s53, s23, 7
    s_lshl_b32 s55, s21, 5
    s_add_u32 s53, s53, s55
    v_lshrrev_b32 v5, 2, v1
    v_add_u32 v5, s53, v5
    v_mul_lo_u32 v5, v5, s54
    v_and_b32 v6, 3, v1
    v_lshl_add_u32 v5, v6, 4, v5
    s_lshl_b32 s53, s24, 7
    s_lshl_b32 s55, s22, 6
    s_add_u32 s53, s53, s55
    v_add_u32 v5, s53, v5
    s_movk_i32 s55, 27648
    s_waitcnt lgkmcnt(0)
    buffer_store_dwordx4 v[36:39], v5, s[16:19], 0 offen sc1
    buffer_store_dwordx4 v[40:43], v5, s[16:19], s55 offen sc1
k1_kernel_zskip_1:
    v_and_b32 v2, 31, v1
    v_lshrrev_b32 v3, 5, v1
    s_lshl_b32 s53, s23, 2
    s_add_u32 s53, s53, s21
    s_mul_i32 s53, s53, 4608
    v_mul_u32_u24 v4, 16, v2
    v_add_u32 v4, s53, v4
    s_lshl_b32 s58, s24, 4
    s_lshl_b32 s59, s22, 3
    s_add_u32 s58, s58, s59
    s_mov_b32 s74, 294912
    s_mov_b32 s75, 0x3ea52b5c
    s_mov_b32 s76, 0x3f803f80
    s_movk_i32 s77, 0x3f80
    s_mov_b32 s78, 0x7fff0000
    s_mov_b32 s57, 52429
    v_add_u32 v5, 0, v3
    v_add_u32 v5, s58, v5
    v_mul_lo_u32 v6, v5, s57
    v_lshrrev_b32 v6, 18, v6
    v_mul_u32_u24 v7, 5, v6
    v_sub_u32 v7, v5, v7
    v_lshrrev_b32 v8, 4, v6
    v_and_b32 v6, 15, v6
    v_lshlrev_b32 v6, 1, v6
    v_cmp_le_u32 vcc, 3, v7
    s_nop 1
    v_addc_co_u32 v6, vcc, 0, v6, vcc
    v_cmp_le_u32 vcc, 3, v7
    v_subrev_u32 v9, 2, v7
    s_nop 0
    v_cndmask_b32 v9, v7, v9, vcc
    v_mul_lo_u32 v6, v6, s74
    v_lshl_add_u32 v6, v9, 9, v6
    v_cmp_eq_u32 vcc, 0, v8
    v_subrev_u32 v9, 1, v8
    s_nop 0
    v_cndmask_b32 v9, v9, 2, vcc
    v_mul_u32_u24 v9, 0x600, v9
    v_add_u32 v6, v6, v9
    v_add_u32 v108, v6, v4
    v_mov_b32 v116, 1.0
    v_mov_b32 v9, s75
    v_cndmask_b32 v116, v116, v9, vcc
    v_mov_b32 v9, s76
    v_cndmask_b32 v120, v9, 0, vcc
    v_mov_b32 v9, s77
    v_cndmask_b32 v124, v9, 0, vcc
    v_cmp_eq_u32 s[66:67], 2, v7
    v_add_u32 v6, 293888, v108
    v_mov_b32 v9, s78
    v_cndmask_b32 v112, v9, v6, s[66:67]
    v_add_u32 v5, 2, v3
    v_add_u32 v5, s58, v5
    v_mul_lo_u32 v6, v5, s57
    v_lshrrev_b32 v6, 18, v6
    v_mul_u32_u24 v7, 5, v6
    v_sub_u32 v7, v5, v7
    v_lshrrev_b32 v8, 4, v6
    v_and_b32 v6, 15, v6
    v_lshlrev_b32 v6, 1, v6
    v_cmp_le_u32 vcc, 3, v7
    s_nop 1
    v_addc_co_u32 v6, vcc, 0, v6, vcc
    v_cmp_le_u32 vcc, 3, v7
    v_subrev_u32 v9, 2, v7
    s_nop 0
    v_cndmask_b32 v9, v7, v9, vcc
    v_mul_lo_u32 v6, v6, s74
    v_lshl_add_u32 v6, v9, 9, v6
    v_cmp_eq_u32 vcc, 0, v8
    v_subrev_u32 v9, 1, v8
    s_nop 0
    v_cndmask_b32 v9, v9, 2, vcc
    v_mul_u32_u24 v9, 0x600, v9
    v_add_u32 v6, v6, v9
    v_add_u32 v109, v6, v4
    v_mov_b32 v117, 1.0
    v_mov_b32 v9, s75
    v_cndmask_b32 v117, v117, v9, vcc
    v_mov_b32 v9, s76
    v_cndmask_b32 v121, v9, 0, vcc
    v_mov_b32 v9, s77
    v_cndmask_b32 v125, v9, 0, vcc
    v_cmp_eq_u32 s[68:69], 2, v7
    v_add_u32 v6, 293888, v109
    v_mov_b32 v9, s78
    v_cndmask_b32 v113, v9, v6, s[68:69]
    v_add_u32 v5, 4, v3
    v_add_u32 v5, s58, v5
    v_mul_lo_u32 v6, v5, s57
    v_lshrrev_b32 v6, 18, v6
    v_mul_u32_u24 v7, 5, v6
    v_sub_u32 v7, v5, v7
    v_lshrrev_b32 v8, 4, v6
    v_and_b32 v6, 15, v6
    v_lshlrev_b32 v6, 1, v6
    v_cmp_le_u32 vcc, 3, v7
    s_nop 1
    v_addc_co_u32 v6, vcc, 0, v6, vcc
    v_cmp_le_u32 vcc, 3, v7
    v_subrev_u32 v9, 2, v7
    s_nop 0
    v_cndmask_b32 v9, v7, v9, vcc
    v_mul_lo_u32 v6, v6, s74
    v_lshl_add_u32 v6, v9, 9, v6
    v_cmp_eq_u32 vcc, 0, v8
    v_subrev_u32 v9, 1, v8
    s_nop 0
    v_cndmask_b32 v9, v9, 2, vcc
    v_mul_u32_u24 v9, 0x600, v9
    v_add_u32 v6, v6, v9
    v_add_u32 v110, v6, v4
    v_mov_b32 v118, 1.0
    v_mov_b32 v9, s75
    v_cndmask_b32 v118, v118, v9, vcc
    v_mov_b32 v9, s76
    v_cndmask_b32 v122, v9, 0, vcc
    v_mov_b32 v9, s77
    v_cndmask_b32 v126, v9, 0, vcc
    v_cmp_eq_u32 s[70:71], 2, v7
    v_add_u32 v6, 293888, v110
    v_mov_b32 v9, s78
    v_cndmask_b32 v114, v9, v6, s[70:71]
    v_add_u32 v5, 6, v3
    v_add_u32 v5, s58, v5
    v_mul_lo_u32 v6, v5, s57
    v_lshrrev_b32 v6, 18, v6
    v_mul_u32_u24 v7, 5, v6
    v_sub_u32 v7, v5, v7
    v_lshrrev_b32 v8, 4, v6
    v_and_b32 v6, 15, v6
    v_lshlrev_b32 v6, 1, v6
    v_cmp_le_u32 vcc, 3, v7
    s_nop 1
    v_addc_co_u32 v6, vcc, 0, v6, vcc
    v_cmp_le_u32 vcc, 3, v7
    v_subrev_u32 v9, 2, v7
    s_nop 0
    v_cndmask_b32 v9, v7, v9, vcc
    v_mul_lo_u32 v6, v6, s74
    v_lshl_add_u32 v6, v9, 9, v6
    v_cmp_eq_u32 vcc, 0, v8
    v_subrev_u32 v9, 1, v8
    s_nop 0
    v_cndmask_b32 v9, v9, 2, vcc
    v_mul_u32_u24 v9, 0x600, v9
    v_add_u32 v6, v6, v9
    v_add_u32 v111, v6, v4
    v_mov_b32 v119, 1.0
    v_mov_b32 v9, s75
    v_cndmask_b32 v119, v119, v9, vcc
    v_mov_b32 v9, s76
    v_cndmask_b32 v123, v9, 0, vcc
    v_mov_b32 v9, s77
    v_cndmask_b32 v127, v9, 0, vcc
    v_cmp_eq_u32 s[72:73], 2, v7
    v_add_u32 v6, 293888, v111
    v_mov_b32 v9, s78
    v_cndmask_b32 v115, v9, v6, s[72:73]
    s_mov_b32 s16, s46
    s_mov_b32 s17, s47
    s_mov_b32 s18, 9437184
    s_mov_b32 s19, 0x20000
    v_mul_f32 v60, v60, v116
    v_mul_f32 v61, v61, v116
    v_mul_f32 v62, v62, v116
    v_mul_f32 v63, v63, v116
    v_mul_f32 v64, v64, v116
    v_mul_f32 v65, v65, v116
    v_mul_f32 v66, v66, v116
    v_mul_f32 v67, v67, v116
    v_cvt_pk_bf16_f32 v128, v60, v61
    v_cvt_pk_bf16_f32 v129, v62, v63
    v_cvt_pk_bf16_f32 v130, v64, v65
    v_cvt_pk_bf16_f32 v131, v66, v67
    s_cmp_eq_u64 s[66:67], 0
    s_cbranch_scc1 k1_kernel_no2_2
    v_mov_b32 v132, v120
    v_mov_b32 v133, v124
    v_mov_b32 v134, v130
    v_mov_b32 v135, v131
    v_cndmask_b32 v130, v130, v120, s[66:67]
    v_cndmask_b32 v131, v131, v124, s[66:67]
    buffer_store_dwordx4 v[132:135], v112, s[16:19], 0 offen sc1
k1_kernel_no2_2:
    buffer_store_dwordx4 v[128:131], v108, s[16:19], 0 offen sc1
    s_nop 1
    v_mul_f32 v68, v68, v117
    v_mul_f32 v69, v69, v117
    v_mul_f32 v70, v70, v117
    v_mul_f32 v71, v71, v117
    v_mul_f32 v72, v72, v117
    v_mul_f32 v73, v73, v117
    v_mul_f32 v74, v74, v117
    v_mul_f32 v75, v75, v117
    v_cvt_pk_bf16_f32 v128, v68, v69
    v_cvt_pk_bf16_f32 v129, v70, v71
    v_cvt_pk_bf16_f32 v130, v72, v73
    v_cvt_pk_bf16_f32 v131, v74, v75
    s_cmp_eq_u64 s[68:69], 0
    s_cbranch_scc1 k1_kernel_no2_3
    v_mov_b32 v132, v121
    v_mov_b32 v133, v125
    v_mov_b32 v134, v130
    v_mov_b32 v135, v131
    v_cndmask_b32 v130, v130, v121, s[68:69]
    v_cndmask_b32 v131, v131, v125, s[68:69]
    buffer_store_dwordx4 v[132:135], v113, s[16:19], 0 offen sc1
k1_kernel_no2_3:
    buffer_store_dwordx4 v[128:131], v109, s[16:19], 0 offen sc1
    s_nop 1
    v_mul_f32 v76, v76, v118
    v_mul_f32 v77, v77, v118
    v_mul_f32 v78, v78, v118
    v_mul_f32 v79, v79, v118
    v_mul_f32 v80, v80, v118
    v_mul_f32 v81, v81, v118
    v_mul_f32 v82, v82, v118
    v_mul_f32 v83, v83, v118
    v_cvt_pk_bf16_f32 v128, v76, v77
    v_cvt_pk_bf16_f32 v129, v78, v79
    v_cvt_pk_bf16_f32 v130, v80, v81
    v_cvt_pk_bf16_f32 v131, v82, v83
    s_cmp_eq_u64 s[70:71], 0
    s_cbranch_scc1 k1_kernel_no2_4
    v_mov_b32 v132, v122
    v_mov_b32 v133, v126
    v_mov_b32 v134, v130
    v_mov_b32 v135, v131
    v_cndmask_b32 v130, v130, v122, s[70:71]
    v_cndmask_b32 v131, v131, v126, s[70:71]
    buffer_store_dwordx4 v[132:135], v114, s[16:19], 0 offen sc1
k1_kernel_no2_4:
    buffer_store_dwordx4 v[128:131], v110, s[16:19], 0 offen sc1
    s_nop 1
    v_mul_f32 v84, v84, v119
    v_mul_f32 v85, v85, v119
    v_mul_f32 v86, v86, v119
    v_mul_f32 v87, v87, v119
    v_mul_f32 v88, v88, v119
    v_mul_f32 v89, v89, v119
    v_mul_f32 v90, v90, v119
    v_mul_f32 v91, v91, v119
    v_cvt_pk_bf16_f32 v128, v84, v85
    v_cvt_pk_bf16_f32 v129, v86, v87
    v_cvt_pk_bf16_f32 v130, v88, v89
    v_cvt_pk_bf16_f32 v131, v90, v91
    s_cmp_eq_u64 s[72:73], 0
    s_cbranch_scc1 k1_kernel_no2_5
    v_mov_b32 v132, v123
    v_mov_b32 v133, v127
    v_mov_b32 v134, v130
    v_mov_b32 v135, v131
    v_cndmask_b32 v130, v130, v123, s[72:73]
    v_cndmask_b32 v131, v131, v127, s[72:73]
    buffer_store_dwordx4 v[132:135], v115, s[16:19], 0 offen sc1
k1_kernel_no2_5:
    buffer_store_dwordx4 v[128:131], v111, s[16:19], 0 offen sc1
    s_nop 1
k1_kernel_end:
k1_kernel_exit:
    s_endpgm
    .text
    .globl k2_kernel
.p2align 8
    .type k2_kernel,@function
k2_kernel:
    s_cmp_ge_u32 s2, 512
    s_cbranch_scc1 k2_kernel_exit
    s_cmp_ge_u32 s2, 256
    s_cbranch_scc1 k2_kernel_grole
    s_load_dwordx2 s[46:47], s[0:1], 88
    v_and_b32 v1, 63, v0
    v_lshrrev_b32 v2, 6, v0
    s_and_b32 s48, s2, 7
    v_readfirstlane_b32 s20, v2
    s_lshr_b32 s49, s2, 3
    s_lshl_b32 s21, s48, 2
    s_and_b32 s50, s49, 3
    s_add_u32 s21, s21, s50
    s_lshr_b32 s22, s49, 2
    s_and_b32 s23, s21, 1
    s_mul_i32 s24, s21, 294912
    s_mul_i32 s25, s20, 4608
    s_add_u32 s25, s25, s24
    v_lshlrev_b32 v2, 4, v1
    v_add_u32 v10, s25, v2
    s_mul_i32 s26, s20, 3072
    s_lshl_b32 s27, s22, 3
    s_add_u32 s27, s27, s20
    s_mul_i32 s28, s27, 4608
    s_add_u32 s28, s28, s24
    s_add_u32 s28, s28, 3072
    v_and_b32 v2, 31, v1
    v_lshrrev_b32 v3, 5, v1
    v_lshlrev_b32 v4, 4, v2
    v_lshl_add_u32 v5, v3, 9, v4
    v_lshl_add_u32 v6, v3, 3, v4
    v_add_u32 v12, 1024, v6
    v_mov_b32 v11, v5
    v_add_u32 v7, s28, v5
    v_add_u32 v8, s28, v12
    s_waitcnt lgkmcnt(0)
    s_mov_b32 s8, s46
    s_mov_b32 s9, s47
    s_mov_b32 s10, 9437184
    s_mov_b32 s11, 0x20000
    s_mov_b32 s40, 0
    s_mov_b32 s41, 24576
    s_mov_b32 s42, 49152
    s_mov_b32 s43, 0
    buffer_load_dwordx4 v[20:23], v7, s[8:11], 0 offen
    buffer_load_dwordx2 v[24:25], v8, s[8:11], 0 offen
    s_mul_i32 s36, s43, 36864
    s_add_u32 m0, s40, s26
    s_nop 0
    buffer_load_dwordx4 v10, s[8:11], s36 offen offset:0 lds
    buffer_load_dwordx4 v10, s[8:11], s36 offen offset:1024 lds
    buffer_load_dwordx4 v10, s[8:11], s36 offen offset:2048 lds
    s_mov_b32 s43, 1
    s_mul_i32 s36, s43, 36864
    s_add_u32 m0, s41, s26
    s_nop 0
    buffer_load_dwordx4 v10, s[8:11], s36 offen offset:0 lds
    buffer_load_dwordx4 v10, s[8:11], s36 offen offset:1024 lds
    buffer_load_dwordx4 v10, s[8:11], s36 offen offset:2048 lds
    s_mov_b32 s43, 2
    s_mov_b32 s44, 0
    s_add_u32 s16, s46, 20971520
    s_addc_u32 s17, s47, 0
    s_mov_b32 s18, 3145728
    s_mov_b32 s19, 0x20000
    v_bfe_u32 v4, v1, 2, 2
    v_lshl_add_u32 v4, v3, 2, v4
    v_mul_u32_u24 v4, 16, v4
    v_and_b32 v5, 3, v1
    v_bfe_u32 v6, v1, 4, 1
    v_and_b32 v7, 1, v5
    v_lshlrev_b32 v7, 1, v7
    v_lshrrev_b32 v8, 1, v5
    v_or_b32 v7, v7, v8
    v_lshlrev_b32 v7, 3, v7
    s_lshl_b32 s29, s23, 3
    v_add_u32 v7, s29, v7
    s_add_u32 s30, s29, 32
    s_cmp_eq_u32 s23, 0
    s_cselect_b32 s31, 40, 0
    v_mov_b32 v8, s31
    v_mov_b32 v9, s30
    v_cmp_eq_u32 vcc, 0, v5
    s_nop 1
    v_cndmask_b32 v8, v8, v9, vcc
    v_cmp_eq_u32 vcc, 1, v6
    s_nop 1
    v_cndmask_b32 v7, v7, v8, vcc
    v_lshrrev_b32 v8, 4, v7
    v_lshlrev_b32 v8, 9, v8
    v_and_b32 v7, 8, v7
    v_add_u32 v7, v7, v8
    v_add_u32 v4, v4, v7
    v_add_u32 v13, 1536, v4
    s_mov_b32 s32, 0
    s_cmp_eq_u32 s23, 0
    s_cselect_b32 s33, -1, 0
    s_cselect_b32 s34, 0, -1
    s_mov_b32 s35, 0
    v_mov_b32 v100, 0
    v_mov_b32 v101, 0
    v_mov_b32 v102, 0
    v_mov_b32 v103, 0
    v_mov_b32 v104, 0
    v_mov_b32 v105, 0
    v_mov_b32 v106, 0
    v_mov_b32 v107, 0
    v_mov_b32 v108, 0
    v_mov_b32 v109, 0
    v_mov_b32 v110, 0
    v_mov_b32 v111, 0
    v_mov_b32 v112, 0
    v_mov_b32 v113, 0
    v_mov_b32 v114, 0
    v_mov_b32 v115, 0
    v_mov_b32 v64, 0
    v_mov_b32 v65, 0
    v_mov_b32 v66, 0
    v_mov_b32 v67, 0
    v_mov_b32 v56, 0
    v_mov_b32 v57, 0
    v_mov_b32 v58, 0
    v_mov_b32 v59, 0
    s_waitcnt vmcnt(3)
    s_barrier
    ds_read_b128 v[28:31], v11 offset:0
    ds_read_b64 v[32:33], v12 offset:0
    ds_read_b128 v[36:39], v11 offset:3072
    ds_read_b64 v[40:41], v12 offset:3072
    ds_read_b64_tr_b16 v[44:45], v13 offset:0
    ds_read_b64_tr_b16 v[46:47], v13 offset:128
    ds_read_b64_tr_b16 v[48:49], v13 offset:256
    ds_read_b64_tr_b16 v[50:51], v13 offset:384
    s_waitcnt lgkmcnt(6)
    v_mfma_f32_32x32x16_bf16 v[68:83], v[28:31], v[20:23], 0
    v_mfma_f32_32x32x8_bf16 v[68:83], v[32:33], v[24:25], v[68:83]
    s_nop 15
    s_nop 3
    v_max3_f32 v124, v68, v69, v70
    v_max3_f32 v124, v124, v71, v72
    v_max3_f32 v124, v124, v73, v74
    v_max3_f32 v124, v124, v75, v76
    v_max3_f32 v124, v124, v77, v78
    v_max3_f32 v124, v124, v79, v80
    v_max3_f32 v124, v124, v81, v82
    v_max_f32 v124, v124, v83
    v_mov_b32 v125, v124
    s_nop 1
    v_permlane32_swap_b32 v124, v125
    s_nop 1
    v_max_f32 v124, v124, v125
    v_sub_f32 v26, 0, v124
    v_cvt_pk_bf16_f32 v116, v26, v26
    v_lshlrev_b32 v116, 16, v116
    v_sub_f32 v117, v26, v116
    v_cvt_pk_bf16_f32 v118, v117, v117
    v_and_b32 v118, 0xffff0000, v118
    v_sub_f32 v118, v117, v118
    v_cvt_pk_bf16_f32 v119, v26, v117
    v_mov_b32 v121, 0
    v_cvt_pk_bf16_f32 v120, v118, v121
    v_cndmask_b32 v24, v24, v119, s[32:33]
    v_cndmask_b32 v25, v25, v120, s[32:33]
    v_cndmask_b32 v20, v20, v119, s[34:35]
    v_cndmask_b32 v21, v21, v120, s[34:35]
    s_nop 1
    v_mfma_f32_32x32x16_bf16 v[68:83], v[28:31], v[20:23], 0
    v_mfma_f32_32x32x8_bf16 v[68:83], v[32:33], v[24:25], v[68:83]
.p2align 6
k2_kernel_loop:
    s_waitcnt vmcnt(0)
    s_barrier
    s_cmp_ge_u32 s43, 8
    s_cbranch_scc1 k2_kernel_noiss_6
    s_mul_i32 s36, s43, 36864
    s_add_u32 m0, s42, s26
    s_nop 0
    buffer_load_dwordx4 v10, s[8:11], s36 offen offset:0 lds
    buffer_load_dwordx4 v10, s[8:11], s36 offen offset:1024 lds
    buffer_load_dwordx4 v10, s[8:11], s36 offen offset:2048 lds
    s_add_u32 s43, s43, 1
k2_kernel_noiss_6:
    v_add_u32 v14, s40, v11
    v_add_u32 v17, s41, v11
    v_add_u32 v15, s40, v12
    v_add_u32 v18, s41, v12
    v_add_u32 v16, s40, v13
    v_add_u32 v19, s41, v13
    s_waitcnt lgkmcnt(4)
    v_mfma_f32_32x32x16_bf16 v[84:99], v[36:39], v[20:23], 0
    ds_read_b128 v[28:31], v14 offset:6144
    ds_read_b64 v[32:33], v15 offset:6144
    v_exp_f32 v68, v68
    v_exp_f32 v69, v69
    v_exp_f32 v70, v70
    v_exp_f32 v71, v71
    v_mfma_f32_32x32x16_bf16 v[100:115], v[56:59], v[64:67], v[100:115]
    ds_read_b64_tr_b16 v[52:53], v16 offset:3072
    ds_read_b64_tr_b16 v[54:55], v16 offset:3200
    ds_read_b64_tr_b16 v[56:57], v16 offset:3328
    ds_read_b64_tr_b16 v[58:59], v16 offset:3456
    v_exp_f32 v72, v72
    v_exp_f32 v73, v73
    v_exp_f32 v74, v74
    v_exp_f32 v75, v75
    v_cvt_pk_bf16_f32 v60, v68, v69
    v_cvt_pk_bf16_f32 v61, v70, v71
    v_mfma_f32_32x32x8_bf16 v[84:99], v[40:41], v[24:25], v[84:99]
    v_cvt_pk_bf16_f32 v62, v72, v73
    v_cvt_pk_bf16_f32 v63, v74, v75
    v_exp_f32 v76, v76
    v_exp_f32 v77, v77
    v_exp_f32 v78, v78
    v_exp_f32 v79, v79
    s_waitcnt lgkmcnt(6)
    v_mfma_f32_32x32x16_bf16 v[100:115], v[44:47], v[60:63], v[100:115]
    v_exp_f32 v80, v80
    v_exp_f32 v81, v81
    v_exp_f32 v82, v82
    v_exp_f32 v83, v83
    v_cvt_pk_bf16_f32 v64, v76, v77
    v_cvt_pk_bf16_f32 v65, v78, v79
    v_cvt_pk_bf16_f32 v66, v80, v81
    v_cvt_pk_bf16_f32 v67, v82, v83
    s_waitcnt lgkmcnt(4)
    v_mfma_f32_32x32x16_bf16 v[68:83], v[28:31], v[20:23], 0
    ds_read_b128 v[36:39], v14 offset:9216
    ds_read_b64 v[40:41], v15 offset:9216
    v_exp_f32 v84, v84
    v_exp_f32 v85, v85
    v_exp_f32 v86, v86
    v_exp_f32 v87, v87
    v_mfma_f32_32x32x16_bf16 v[100:115], v[48:51], v[64:67], v[100:115]
    ds_read_b64_tr_b16 v[44:45], v16 offset:6144
    ds_read_b64_tr_b16 v[46:47], v16 offset:6272
    ds_read_b64_tr_b16 v[48:49], v16 offset:6400
    ds_read_b64_tr_b16 v[50:51], v16 offset:6528
    v_exp_f32 v88, v88
    v_exp_f32 v89, v89
    v_exp_f32 v90, v90
    v_exp_f32 v91, v91
    v_cvt_pk_bf16_f32 v60, v84, v85
    v_cvt_pk_bf16_f32 v61, v86, v87
    v_mfma_f32_32x32x8_bf16 v[68:83], v[32:33], v[24:25], v[68:83]
    v_cvt_pk_bf16_f32 v62, v88, v89
    v_cvt_pk_bf16_f32 v63, v90, v91
    v_exp_f32 v92, v92
    v_exp_f32 v93, v93
    v_exp_f32 v94, v94
    v_exp_f32 v95, v95
    s_waitcnt lgkmcnt(6)
    v_mfma_f32_32x32x16_bf16 v[100:115], v[52:55], v[60:63], v[100:115]
    v_exp_f32 v96, v96
    v_exp_f32 v97, v97
    v_exp_f32 v98, v98
    v_exp_f32 v99, v99
    v_cvt_pk_bf16_f32 v64, v92, v93
    v_cvt_pk_bf16_f32 v65, v94, v95
    v_cvt_pk_bf16_f32 v66, v96, v97
    v_cvt_pk_bf16_f32 v67, v98, v99
    s_waitcnt lgkmcnt(4)
    v_mfma_f32_32x32x16_bf16 v[84:99], v[36:39], v[20:23], 0
    ds_read_b128 v[28:31], v14 offset:12288
    ds_read_b64 v[32:33], v15 offset:12288
    v_exp_f32 v68, v68
    v_exp_f32 v69, v69
    v_exp_f32 v70, v70
    v_exp_f32 v71, v71
    v_mfma_f32_32x32x16_bf16 v[100:115], v[56:59], v[64:67], v[100:115]
    ds_read_b64_tr_b16 v[52:53], v16 offset:9216
    ds_read_b64_tr_b16 v[54:55], v16 offset:9344
    ds_read_b64_tr_b16 v[56:57], v16 offset:9472
    ds_read_b64_tr_b16 v[58:59], v16 offset:9600
    v_exp_f32 v72, v72
    v_exp_f32 v73, v73
    v_exp_f32 v74, v74
    v_exp_f32 v75, v75
    v_cvt_pk_bf16_f32 v60, v68, v69
    v_cvt_pk_bf16_f32 v61, v70, v71
    v_mfma_f32_32x32x8_bf16 v[84:99], v[40:41], v[24:25], v[84:99]
    v_cvt_pk_bf16_f32 v62, v72, v73
    v_cvt_pk_bf16_f32 v63, v74, v75
    v_exp_f32 v76, v76
    v_exp_f32 v77, v77
    v_exp_f32 v78, v78
    v_exp_f32 v79, v79
    s_waitcnt lgkmcnt(6)
    v_mfma_f32_32x32x16_bf16 v[100:115], v[44:47], v[60:63], v[100:115]
    v_exp_f32 v80, v80
    v_exp_f32 v81, v81
    v_exp_f32 v82, v82
    v_exp_f32 v83, v83
    v_cvt_pk_bf16_f32 v64, v76, v77
    v_cvt_pk_bf16_f32 v65, v78, v79
    v_cvt_pk_bf16_f32 v66, v80, v81
    v_cvt_pk_bf16_f32 v67, v82, v83
    s_waitcnt lgkmcnt(4)
    v_mfma_f32_32x32x16_bf16 v[68:83], v[28:31], v[20:23], 0
    ds_read_b128 v[36:39], v14 offset:15360
    ds_read_b64 v[40:41], v15 offset:15360
    v_exp_f32 v84, v84
    v_exp_f32 v85, v85
    v_exp_f32 v86, v86
    v_exp_f32 v87, v87
    v_mfma_f32_32x32x16_bf16 v[100:115], v[48:51], v[64:67], v[100:115]
    ds_read_b64_tr_b16 v[44:45], v16 offset:12288
    ds_read_b64_tr_b16 v[46:47], v16 offset:12416
    ds_read_b64_tr_b16 v[48:49], v16 offset:12544
    ds_read_b64_tr_b16 v[50:51], v16 offset:12672
    v_exp_f32 v88, v88
    v_exp_f32 v89, v89
    v_exp_f32 v90, v90
    v_exp_f32 v91, v91
    v_cvt_pk_bf16_f32 v60, v84, v85
    v_cvt_pk_bf16_f32 v61, v86, v87
    v_mfma_f32_32x32x8_bf16 v[68:83], v[32:33], v[24:25], v[68:83]
    v_cvt_pk_bf16_f32 v62, v88, v89
    v_cvt_pk_bf16_f32 v63, v90, v91
    v_exp_f32 v92, v92
    v_exp_f32 v93, v93
    v_exp_f32 v94, v94
    v_exp_f32 v95, v95
    s_waitcnt lgkmcnt(6)
    v_mfma_f32_32x32x16_bf16 v[100:115], v[52:55], v[60:63], v[100:115]
    v_exp_f32 v96, v96
    v_exp_f32 v97, v97
    v_exp_f32 v98, v98
    v_exp_f32 v99, v99
    v_cvt_pk_bf16_f32 v64, v92, v93
    v_cvt_pk_bf16_f32 v65, v94, v95
    v_cvt_pk_bf16_f32 v66, v96, v97
    v_cvt_pk_bf16_f32 v67, v98, v99
    s_waitcnt lgkmcnt(4)
    v_mfma_f32_32x32x16_bf16 v[84:99], v[36:39], v[20:23], 0
    ds_read_b128 v[28:31], v14 offset:18432
    ds_read_b64 v[32:33], v15 offset:18432
    v_exp_f32 v68, v68
    v_exp_f32 v69, v69
    v_exp_f32 v70, v70
    v_exp_f32 v71, v71
    v_mfma_f32_32x32x16_bf16 v[100:115], v[56:59], v[64:67], v[100:115]
    ds_read_b64_tr_b16 v[52:53], v16 offset:15360
    ds_read_b64_tr_b16 v[54:55], v16 offset:15488
    ds_read_b64_tr_b16 v[56:57], v16 offset:15616
    ds_read_b64_tr_b16 v[58:59], v16 offset:15744
    v_exp_f32 v72, v72
    v_exp_f32 v73, v73
    v_exp_f32 v74, v74
    v_exp_f32 v75, v75
    v_cvt_pk_bf16_f32 v60, v68, v69
    v_cvt_pk_bf16_f32 v61, v70, v71
    v_mfma_f32_32x32x8_bf16 v[84:99], v[40:41], v[24:25], v[84:99]
    v_cvt_pk_bf16_f32 v62, v72, v73
    v_cvt_pk_bf16_f32 v63, v74, v75
    v_exp_f32 v76, v76
    v_exp_f32 v77, v77
    v_exp_f32 v78, v78
    v_exp_f32 v79, v79
    s_waitcnt lgkmcnt(6)
    v_mfma_f32_32x32x16_bf16 v[100:115], v[44:47], v[60:63], v[100:115]
    v_exp_f32 v80, v80
    v_exp_f32 v81, v81
    v_exp_f32 v82, v82
    v_exp_f32 v83, v83
    v_cvt_pk_bf16_f32 v64, v76, v77
    v_cvt_pk_bf16_f32 v65, v78, v79
    v_cvt_pk_bf16_f32 v66, v80, v81
    v_cvt_pk_bf16_f32 v67, v82, v83
    s_waitcnt lgkmcnt(4)
    v_mfma_f32_32x32x16_bf16 v[68:83], v[28:31], v[20:23], 0
    ds_read_b128 v[36:39], v14 offset:21504
    ds_read_b64 v[40:41], v15 offset:21504
    v_exp_f32 v84, v84
    v_exp_f32 v85, v85
    v_exp_f32 v86, v86
    v_exp_f32 v87, v87
    v_mfma_f32_32x32x16_bf16 v[100:115], v[48:51], v[64:67], v[100:115]
    ds_read_b64_tr_b16 v[44:45], v16 offset:18432
    ds_read_b64_tr_b16 v[46:47], v16 offset:18560
    ds_read_b64_tr_b16 v[48:49], v16 offset:18688
    ds_read_b64_tr_b16 v[50:51], v16 offset:18816
    v_exp_f32 v88, v88
    v_exp_f32 v89, v89
    v_exp_f32 v90, v90
    v_exp_f32 v91, v91
    v_cvt_pk_bf16_f32 v60, v84, v85
    v_cvt_pk_bf16_f32 v61, v86, v87
    v_mfma_f32_32x32x8_bf16 v[68:83], v[32:33], v[24:25], v[68:83]
    v_cvt_pk_bf16_f32 v62, v88, v89
    v_cvt_pk_bf16_f32 v63, v90, v91
    v_exp_f32 v92, v92
    v_exp_f32 v93, v93
    v_exp_f32 v94, v94
    v_exp_f32 v95, v95
    s_waitcnt lgkmcnt(6)
    v_mfma_f32_32x32x16_bf16 v[100:115], v[52:55], v[60:63], v[100:115]
    v_exp_f32 v96, v96
    v_exp_f32 v97, v97
    v_exp_f32 v98, v98
    v_exp_f32 v99, v99
    v_cvt_pk_bf16_f32 v64, v92, v93
    v_cvt_pk_bf16_f32 v65, v94, v95
    v_cvt_pk_bf16_f32 v66, v96, v97
    v_cvt_pk_bf16_f32 v67, v98, v99
    s_waitcnt lgkmcnt(4)
    v_mfma_f32_32x32x16_bf16 v[84:99], v[36:39], v[20:23], 0
    ds_read_b128 v[28:31], v17 offset:0
    ds_read_b64 v[32:33], v18 offset:0
    v_exp_f32 v68, v68
    v_exp_f32 v69, v69
    v_exp_f32 v70, v70
    v_exp_f32 v71, v71
    v_mfma_f32_32x32x16_bf16 v[100:115], v[56:59], v[64:67], v[100:115]
    ds_read_b64_tr_b16 v[52:53], v16 offset:21504
    ds_read_b64_tr_b16 v[54:55], v16 offset:21632
    ds_read_b64_tr_b16 v[56:57], v16 offset:21760
    ds_read_b64_tr_b16 v[58:59], v16 offset:21888
    v_exp_f32 v72, v72
    v_exp_f32 v73, v73
    v_exp_f32 v74, v74
    v_exp_f32 v75, v75
    v_cvt_pk_bf16_f32 v60, v68, v69
    v_cvt_pk_bf16_f32 v61, v70, v71
    v_mfma_f32_32x32x8_bf16 v[84:99], v[40:41], v[24:25], v[84:99]
    v_cvt_pk_bf16_f32 v62, v72, v73
    v_cvt_pk_bf16_f32 v63, v74, v75
    v_exp_f32 v76, v76
    v_exp_f32 v77, v77
    v_exp_f32 v78, v78
    v_exp_f32 v79, v79
    s_waitcnt lgkmcnt(6)
    v_mfma_f32_32x32x16_bf16 v[100:115], v[44:47], v[60:63], v[100:115]
    v_exp_f32 v80, v80
    v_exp_f32 v81, v81
    v_exp_f32 v82, v82
    v_exp_f32 v83, v83
    v_cvt_pk_bf16_f32 v64, v76, v77
    v_cvt_pk_bf16_f32 v65, v78, v79
    v_cvt_pk_bf16_f32 v66, v80, v81
    v_cvt_pk_bf16_f32 v67, v82, v83
    s_waitcnt lgkmcnt(4)
    v_mfma_f32_32x32x16_bf16 v[68:83], v[28:31], v[20:23], 0
    ds_read_b128 v[36:39], v17 offset:3072
    ds_read_b64 v[40:41], v18 offset:3072
    v_exp_f32 v84, v84
    v_exp_f32 v85, v85
    v_exp_f32 v86, v86
    v_exp_f32 v87, v87
    v_mfma_f32_32x32x16_bf16 v[100:115], v[48:51], v[64:67], v[100:115]
    ds_read_b64_tr_b16 v[44:45], v19 offset:0
    ds_read_b64_tr_b16 v[46:47], v19 offset:128
    ds_read_b64_tr_b16 v[48:49], v19 offset:256
    ds_read_b64_tr_b16 v[50:51], v19 offset:384
    v_exp_f32 v88, v88
    v_exp_f32 v89, v89
    v_exp_f32 v90, v90
    v_exp_f32 v91, v91
    v_cvt_pk_bf16_f32 v60, v84, v85
    v_cvt_pk_bf16_f32 v61, v86, v87
    v_mfma_f32_32x32x8_bf16 v[68:83], v[32:33], v[24:25], v[68:83]
    v_cvt_pk_bf16_f32 v62, v88, v89
    v_cvt_pk_bf16_f32 v63, v90, v91
    v_exp_f32 v92, v92
    v_exp_f32 v93, v93
    v_exp_f32 v94, v94
    v_exp_f32 v95, v95
    s_waitcnt lgkmcnt(6)
    v_mfma_f32_32x32x16_bf16 v[100:115], v[52:55], v[60:63], v[100:115]
    v_exp_f32 v96, v96
    v_exp_f32 v97, v97
    v_exp_f32 v98, v98
    v_exp_f32 v99, v99
    v_cvt_pk_bf16_f32 v64, v92, v93
    v_cvt_pk_bf16_f32 v65, v94, v95
    v_cvt_pk_bf16_f32 v66, v96, v97
    v_cvt_pk_bf16_f32 v67, v98, v99
    s_mov_b32 s45, s40
    s_mov_b32 s40, s41
    s_mov_b32 s41, s42
    s_mov_b32 s42, s45
    s_add_u32 s44, s44, 1
    s_cmp_lt_u32 s44, 8
    s_cbranch_scc1 k2_kernel_loop
    s_nop 0
    v_mfma_f32_32x32x16_bf16 v[100:115], v[56:59], v[64:67], v[100:115]
    s_waitcnt lgkmcnt(0)
    s_nop 15
    v_mov_b32 v116, v108
    v_mov_b32 v117, v108
    s_nop 1
    v_permlane32_swap_b32 v116, v117
    s_nop 1
    v_mov_b32 v118, 0x53800000
    v_cmp_nlt_f32 vcc, v117, v118
    v_mov_b32 v119, 0x3a800000
    v_cmp_lt_f32 s[50:51], v117, v119
    s_nop 1
    s_or_b64 vcc, vcc, s[50:51]
    s_cmp_eq_u64 vcc, 0
    s_cbranch_scc1 k2_kernel_fin
    s_mov_b32 s52, s26
    v_add_u32 v14, s52, v11
    v_add_u32 v15, s52, v12
    v_add_u32 v16, s52, v13
    s_mul_i32 s53, s20, 4608
    v_subrev_u32 v17, s53, v10
    v_mov_b32 v126, 0xff7fffff
    s_mov_b32 s54, 0
k2_kernel_fb1:
    s_mul_i32 s36, s54, 4608
    s_mov_b32 m0, s52
    s_waitcnt lgkmcnt(0)
    buffer_load_dwordx4 v17, s[8:11], s36 offen offset:0 lds
    buffer_load_dwordx4 v17, s[8:11], s36 offen offset:1024 lds
    buffer_load_dwordx4 v17, s[8:11], s36 offen offset:2048 lds
    s_waitcnt vmcnt(0)
    ds_read_b128 v[28:31], v14 offset:0
    ds_read_b64 v[32:33], v15 offset:0
    s_waitcnt lgkmcnt(0)
    v_mfma_f32_32x32x16_bf16 v[68:83], v[28:31], v[20:23], 0
    v_mfma_f32_32x32x8_bf16 v[68:83], v[32:33], v[24:25], v[68:83]
    s_nop 15
    s_nop 3
    v_max3_f32 v124, v68, v69, v70
    v_max3_f32 v124, v124, v71, v72
    v_max3_f32 v124, v124, v73, v74
    v_max3_f32 v124, v124, v75, v76
    v_max3_f32 v124, v124, v77, v78
    v_max3_f32 v124, v124, v79, v80
    v_max3_f32 v124, v124, v81, v82
    v_max_f32 v124, v124, v83
    v_mov_b32 v125, v124
    s_nop 1
    v_permlane32_swap_b32 v124, v125
    s_nop 1
    v_max_f32 v124, v124, v125
    v_max_f32 v126, v126, v124
    s_add_u32 s54, s54, 1
    s_cmp_lt_u32 s54, 64
    s_cbranch_scc1 k2_kernel_fb1
    v_sub_f32 v26, v26, v126
    v_cvt_pk_bf16_f32 v116, v26, v26
    v_lshlrev_b32 v116, 16, v116
    v_sub_f32 v117, v26, v116
    v_cvt_pk_bf16_f32 v118, v117, v117
    v_and_b32 v118, 0xffff0000, v118
    v_sub_f32 v118, v117, v118
    v_cvt_pk_bf16_f32 v119, v26, v117
    v_mov_b32 v121, 0
    v_cvt_pk_bf16_f32 v120, v118, v121
    v_cndmask_b32 v24, v24, v119, s[32:33]
    v_cndmask_b32 v25, v25, v120, s[32:33]
    v_cndmask_b32 v20, v20, v119, s[34:35]
    v_cndmask_b32 v21, v21, v120, s[34:35]
    s_nop 1
    v_mov_b32 v100, 0
    v_mov_b32 v101, 0
    v_mov_b32 v102, 0
    v_mov_b32 v103, 0
    v_mov_b32 v104, 0
    v_mov_b32 v105, 0
    v_mov_b32 v106, 0
    v_mov_b32 v107, 0
    v_mov_b32 v108, 0
    v_mov_b32 v109, 0
    v_mov_b32 v110, 0
    v_mov_b32 v111, 0
    v_mov_b32 v112, 0
    v_mov_b32 v113, 0
    v_mov_b32 v114, 0
    v_mov_b32 v115, 0
    s_mov_b32 s54, 0
k2_kernel_fb2:
    s_mul_i32 s36, s54, 4608
    s_mov_b32 m0, s52
    s_waitcnt lgkmcnt(0)
    buffer_load_dwordx4 v17, s[8:11], s36 offen offset:0 lds
    buffer_load_dwordx4 v17, s[8:11], s36 offen offset:1024 lds
    buffer_load_dwordx4 v17, s[8:11], s36 offen offset:2048 lds
    s_waitcnt vmcnt(0)
    ds_read_b128 v[28:31], v14 offset:0
    ds_read_b64 v[32:33], v15 offset:0
    ds_read_b64_tr_b16 v[44:45], v16 offset:0
    ds_read_b64_tr_b16 v[46:47], v16 offset:128
    ds_read_b64_tr_b16 v[48:49], v16 offset:256
    ds_read_b64_tr_b16 v[50:51], v16 offset:384
    s_waitcnt lgkmcnt(0)
    v_mfma_f32_32x32x16_bf16 v[68:83], v[28:31], v[20:23], 0
    v_mfma_f32_32x32x8_bf16 v[68:83], v[32:33], v[24:25], v[68:83]
    s_nop 15
    s_nop 3
    v_exp_f32 v68, v68
    v_exp_f32 v69, v69
    v_exp_f32 v70, v70
    v_exp_f32 v71, v71
    v_exp_f32 v72, v72
    v_exp_f32 v73, v73
    v_exp_f32 v74, v74
    v_exp_f32 v75, v75
    v_exp_f32 v76, v76
    v_exp_f32 v77, v77
    v_exp_f32 v78, v78
    v_exp_f32 v79, v79
    v_exp_f32 v80, v80
    v_exp_f32 v81, v81
    v_exp_f32 v82, v82
    v_exp_f32 v83, v83
    s_nop 0
    v_cvt_pk_bf16_f32 v60, v68, v69
    v_cvt_pk_bf16_f32 v61, v70, v71
    v_cvt_pk_bf16_f32 v62, v72, v73
    v_cvt_pk_bf16_f32 v63, v74, v75
    v_cvt_pk_bf16_f32 v64, v76, v77
    v_cvt_pk_bf16_f32 v65, v78, v79
    v_cvt_pk_bf16_f32 v66, v80, v81
    v_cvt_pk_bf16_f32 v67, v82, v83
    s_nop 1
    v_mfma_f32_32x32x16_bf16 v[100:115], v[44:47], v[60:63], v[100:115]
    v_mfma_f32_32x32x16_bf16 v[100:115], v[48:51], v[64:67], v[100:115]
    s_add_u32 s54, s54, 1
    s_cmp_lt_u32 s54, 64
    s_cbranch_scc1 k2_kernel_fb2
    s_nop 15
    v_mov_b32 v116, v108
    v_mov_b32 v117, v108
    s_nop 1
    v_permlane32_swap_b32 v116, v117
    s_nop 1
k2_kernel_fin:
    v_rcp_f32 v118, v117
    s_nop 0
    v_mul_f32 v100, v100, v118
    v_mul_f32 v101, v101, v118
    v_mul_f32 v102, v102, v118
    v_mul_f32 v103, v103, v118
    v_mul_f32 v104, v104, v118
    v_mul_f32 v105, v105, v118
    v_mul_f32 v106, v106, v118
    v_mul_f32 v107, v107, v118
    v_mul_f32 v108, v108, v118
    v_mul_f32 v109, v109, v118
    v_mul_f32 v110, v110, v118
    v_mul_f32 v111, v111, v118
    v_cvt_pk_bf16_f32 v60, v100, v101
    v_cvt_pk_bf16_f32 v61, v102, v103
    v_cvt_pk_bf16_f32 v62, v104, v105
    v_cvt_pk_bf16_f32 v63, v106, v107
    v_cvt_pk_bf16_f32 v64, v108, v109
    v_cvt_pk_bf16_f32 v65, v110, v111
    v_mov_b32 v66, 0
    v_mov_b32 v67, 0
    v_and_b32 v2, 31, v1
    v_mul_u32_u24 v2, 48, v2
    v_lshrrev_b32 v3, 5, v1
    v_lshl_add_u32 v2, v3, 4, v2
    v_add_u32 v2, s26, v2
    ds_write_b128 v2, v[60:63]
    v_and_b32 v3, 31, v1
    v_mul_u32_u24 v3, 48, v3
    v_add_u32 v3, s26, v3
    s_mov_b32 s52, -1
    s_mov_b32 s53, 0
    s_mov_b64 exec, s[52:53]
    ds_write_b128 v3, v[64:67] offset:32
    s_mov_b64 exec, -1
    v_lshlrev_b32 v4, 4, v1
    v_add_u32 v2, s26, v4
    s_waitcnt lgkmcnt(0)
    ds_read_b128 v[68:71], v2
    ds_read_b128 v[72:75], v2 offset:1024
    s_lshl_b32 s54, s21, 6
    s_add_u32 s54, s54, s27
    s_mul_i32 s54, s54, 1536
    v_add_u32 v4, s54, v4
    s_waitcnt lgkmcnt(0)
    buffer_store_dwordx4 v[68:71], v4, s[16:19], 0 offen sc1
    s_mov_b64 exec, s[52:53]
    buffer_store_dwordx4 v[72:75], v4, s[16:19], 0 offen offset:1024 sc1
    s_mov_b64 exec, -1
    s_add_u32 s12, s46, 30408704
    s_addc_u32 s13, s47, 0
    s_mov_b32 s14, 16384
    s_mov_b32 s15, 0x20000
    s_lshr_b32 s52, s27, 1
    s_lshl_b32 s52, s52, 7
    s_add_u32 s52, s52, 8192
    v_mov_b32 v2, s52
    v_mov_b32 v3, 1
    s_waitcnt vmcnt(0)
    s_mov_b64 exec, 1
    buffer_atomic_add v3, v2, s[12:15], 0 offen sc1
    s_branch k2_kernel_exit
k2_kernel_grole:
    s_sub_u32 s2, s2, 256
    s_load_dwordx2 s[36:37], s[0:1], 0
    s_load_dwordx4 s[40:43], s[0:1], 32
    s_load_dwordx2 s[38:39], s[0:1], 48
    s_load_dwordx2 s[46:47], s[0:1], 88
    s_load_dwordx2 s[34:35], s[0:1], 16
    s_load_dwordx2 s[76:77], s[0:1], 56
    s_load_dwordx2 s[78:79], s[0:1], 72
    s_setprio 2
    v_and_b32 v1, 63, v0
    v_lshrrev_b32 v2, 6, v0
    s_and_b32 s48, s2, 7
    v_readfirstlane_b32 s20, v2
    s_lshr_b32 s49, s2, 3
    s_lshl_b32 s23, s48, 2
    s_and_b32 s50, s49, 3
    s_add_u32 s23, s23, s50
    s_lshr_b32 s24, s49, 2
    s_and_b32 s21, s20, 3
    s_lshl_b32 s27, s23, 6
    s_lshl_b32 s28, s24, 8
    s_mov_b32 s62, 0
    s_mov_b32 s63, 24576
    s_mov_b32 s64, 49152
    s_waitcnt lgkmcnt(0)
    s_add_u32 s12, s46, 30408704
    s_addc_u32 s13, s47, 0
    s_mov_b32 s14, 16384
    s_mov_b32 s15, 0x20000
    s_mov_b32 s4, s36
    s_mov_b32 s5, s37
    s_mov_b32 s6, 2621440
    s_mov_b32 s7, 0x20000
    s_mov_b32 s72, s40
    s_mov_b32 s73, s41
    s_mov_b32 s74, 2211840
    s_mov_b32 s75, 0x20000
    s_cmp_eq_u32 s24, 7
    s_cselect_b32 s25, 0, 1
    s_cmp_ge_u32 s20, 4
    s_cselect_b32 s26, s25, 0
    v_lshrrev_b32 v2, 3, v1
    v_and_b32 v3, 7, v1
    s_mul_i32 s67, s21, 16
    s_add_u32 s67, s67, s27
    v_add_u32 v4, s67, v2
    s_mov_b32 s68, 1280
    v_mul_lo_u32 v4, v4, s68
    v_lshrrev_b32 v5, 1, v2
    v_xor_b32 v6, v5, v3
    v_lshl_add_u32 v6, v6, 4, v4
    v_add_u32 v40, 0, v6
    v_or_b32 v6, 4, v5
    v_xor_b32 v6, v6, v3
    v_lshl_add_u32 v6, v6, 4, v4
    v_add_u32 v41, 9216, v6
    s_mul_i32 s60, s21, 2048
    v_lshrrev_b32 v2, 3, v1
    v_and_b32 v3, 7, v1
    s_mul_i32 s67, s21, 16
    s_add_u32 s67, s67, s27
    v_add_u32 v4, s67, v2
    s_mov_b32 s68, 4096
    v_mul_lo_u32 v4, v4, s68
    v_lshrrev_b32 v5, 1, v2
    v_xor_b32 v6, v5, v3
    v_lshl_add_u32 v6, v6, 4, v4
    v_add_u32 v42, 0, v6
    v_or_b32 v6, 4, v5
    v_xor_b32 v6, v6, v3
    v_lshl_add_u32 v6, v6, 4, v4
    v_add_u32 v43, 31744, v6
    s_mul_i32 s60, s21, 2048
    v_lshrrev_b32 v2, 4, v1
    v_and_b32 v3, 15, v1
    v_lshlrev_b32 v5, 2, v2
    v_xor_b32 v3, v3, v5
    s_mul_i32 s67, s21, 16
    v_add_u32 v4, s67, v2
    s_mov_b32 s68, 3456
    v_mul_lo_u32 v4, v4, s68
    v_lshl_add_u32 v4, v3, 4, v4
    v_add_u32 v44, s28, v4
    v_add_u32 v45, 12800, v44
    v_add_u32 v46, 25600, v44
    v_add_u32 v47, 38400, v44
    s_mul_i32 s61, s21, 4096
    s_add_u32 s61, s61, 8192
    s_lshl_b32 s30, s24, 19
    s_lshl_b32 s31, s21, 12
    s_add_u32 s30, s30, s31
    v_lshlrev_b32 v2, 4, v1
    v_add_u32 v48, s30, v2
    s_mov_b32 s65, 0
    s_mov_b32 s66, 0
    s_cmp_eq_u32 s26, 0
    s_cbranch_scc1 k2_kernel_g_pre
    s_add_u32 m0, s62, s61
    s_nop 0
    buffer_load_dwordx4 v44, s[72:75], s66 offen offset:0 lds
    buffer_load_dwordx4 v45, s[72:75], s66 offen offset:1024 lds
    buffer_load_dwordx4 v46, s[72:75], s66 offen offset:2048 lds
    buffer_load_dwordx4 v47, s[72:75], s66 offen offset:3072 lds
    s_add_u32 s66, s66, 221184
    s_add_u32 m0, s63, s61
    s_nop 0
    buffer_load_dwordx4 v44, s[72:75], s66 offen offset:0 lds
    buffer_load_dwordx4 v45, s[72:75], s66 offen offset:1024 lds
    buffer_load_dwordx4 v46, s[72:75], s66 offen offset:2048 lds
    buffer_load_dwordx4 v47, s[72:75], s66 offen offset:3072 lds
    s_add_u32 s66, s66, 221184
k2_kernel_g_pre:
    s_cmp_lt_u32 s20, 4
    s_cselect_b32 s26, s25, 0
    s_cmp_eq_u32 s26, 0
    s_cbranch_scc1 k2_kernel_g_pre2
    s_add_u32 m0, s62, s60
    s_nop 0
    buffer_load_dwordx4 v40, s[4:7], s65 offen offset:0 lds
    buffer_load_dwordx4 v41, s[4:7], s65 offen offset:1024 lds
    s_add_u32 s65, s65, 128
    s_add_u32 m0, s63, s60
    s_nop 0
    buffer_load_dwordx4 v40, s[4:7], s65 offen offset:0 lds
    buffer_load_dwordx4 v41, s[4:7], s65 offen offset:1024 lds
    s_add_u32 s65, s65, 128
k2_kernel_g_pre2:
    s_add_u32 s8, s46, 13107200
    s_addc_u32 s9, s47, 0
    s_mov_b32 s10, 3538944
    s_mov_b32 s11, 0x20000
    s_add_u32 s16, s46, 16777216
    s_addc_u32 s17, s47, 0
    s_mov_b32 s18, 3670016
    s_mov_b32 s19, 0x20000
    s_lshl_b32 s22, s2, 3
    s_add_u32 s22, s22, s20
    s_mul_i32 s52, s22, 1728
    v_lshlrev_b32 v4, 4, v1
    v_add_u32 v2, s52, v4
    v_cmp_gt_u32 s[54:55], 44, v1
    v_mov_b32 v12, 0
    v_mov_b32 v13, 0
    v_mov_b32 v14, 0
    v_mov_b32 v15, 0
    buffer_load_dwordx4 v[8:11], v2, s[8:11], 0 offen
    s_mov_b64 s[56:57], exec
    s_mov_b64 exec, s[54:55]
    buffer_load_dwordx4 v[12:15], v2, s[8:11], 0 offen offset:1024
    s_mov_b64 exec, s[56:57]
    s_lshr_b32 s52, s22, 6
    s_lshl_b32 s52, s52, 14
    s_and_b32 s53, s22, 63
    s_lshl_b32 s53, s53, 8
    s_add_u32 s52, s52, s53
    s_and_b32 s53, s22, 3
    s_lshl_b32 s53, s53, 2
    v_and_b32 v4, 15, v1
    v_xor_b32 v4, s53, v4
    v_lshlrev_b32 v4, 4, v4
    v_lshrrev_b32 v5, 4, v1
    v_lshlrev_b32 v5, 19, v5
    v_add_u32 v4, v4, v5
    v_add_u32 v3, s52, v4
    s_waitcnt vmcnt(0)
    v_lshlrev_b32 v16, 16, v8
    v_and_b32 v17, 0xffff0000, v8
    v_lshlrev_b32 v18, 16, v9
    v_and_b32 v19, 0xffff0000, v9
    v_lshlrev_b32 v20, 16, v10
    v_and_b32 v21, 0xffff0000, v10
    v_lshlrev_b32 v22, 16, v11
    v_and_b32 v23, 0xffff0000, v11
    v_lshlrev_b32 v24, 16, v12
    v_and_b32 v25, 0xffff0000, v12
    v_lshlrev_b32 v26, 16, v13
    v_and_b32 v27, 0xffff0000, v13
    v_lshlrev_b32 v28, 16, v14
    v_and_b32 v29, 0xffff0000, v14
    v_lshlrev_b32 v30, 16, v15
    v_and_b32 v31, 0xffff0000, v15
    v_add_f32 v8, v16, v17
    v_add_f32 v9, v18, v19
    v_add_f32 v8, v8, v20
    v_add_f32 v9, v9, v21
    v_add_f32 v8, v8, v22
    v_add_f32 v9, v9, v23
    v_add_f32 v8, v8, v24
    v_add_f32 v9, v9, v25
    v_add_f32 v8, v8, v26
    v_add_f32 v9, v9, v27
    v_add_f32 v8, v8, v28
    v_add_f32 v9, v9, v29
    v_add_f32 v8, v8, v30
    v_add_f32 v9, v9, v31
    v_add_f32 v8, v8, v9
    s_nop 1
    v_add_f32_dpp v8, v8, v8 row_ror:8 row_mask:0xf bank_mask:0xf
    s_nop 1
    v_add_f32_dpp v8, v8, v8 row_ror:4 row_mask:0xf bank_mask:0xf
    s_nop 1
    v_add_f32_dpp v8, v8, v8 row_ror:2 row_mask:0xf bank_mask:0xf
    s_nop 1
    v_add_f32_dpp v8, v8, v8 row_ror:1 row_mask:0xf bank_mask:0xf
    v_mov_b32 v9, v8
    s_nop 1
    v_permlane16_swap_b32 v8, v9
    s_nop 1
    v_add_f32 v8, v8, v9
    v_mov_b32 v9, v8
    s_nop 1
    v_permlane32_swap_b32 v8, v9
    s_nop 1
    v_add_f32 v8, v8, v9
    v_mul_f32 v8, 0x3a97b426, v8
    v_sub_f32 v16, v16, v8
    v_sub_f32 v17, v17, v8
    v_sub_f32 v18, v18, v8
    v_sub_f32 v19, v19, v8
    v_sub_f32 v20, v20, v8
    v_sub_f32 v21, v21, v8
    v_sub_f32 v22, v22, v8
    v_sub_f32 v23, v23, v8
    v_sub_f32 v24, v24, v8
    v_sub_f32 v25, v25, v8
    v_sub_f32 v26, v26, v8
    v_sub_f32 v27, v27, v8
    v_sub_f32 v28, v28, v8
    v_sub_f32 v29, v29, v8
    v_sub_f32 v30, v30, v8
    v_sub_f32 v31, v31, v8
    v_cndmask_b32 v24, 0, v24, s[54:55]
    v_cndmask_b32 v25, 0, v25, s[54:55]
    v_cndmask_b32 v26, 0, v26, s[54:55]
    v_cndmask_b32 v27, 0, v27, s[54:55]
    v_cndmask_b32 v28, 0, v28, s[54:55]
    v_cndmask_b32 v29, 0, v29, s[54:55]
    v_cndmask_b32 v30, 0, v30, s[54:55]
    v_cndmask_b32 v31, 0, v31, s[54:55]
    v_mul_f32 v8, v16, v16
    v_mul_f32 v9, v17, v17
    v_fmac_f32 v8, v18, v18
    v_fmac_f32 v9, v19, v19
    v_fmac_f32 v8, v20, v20
    v_fmac_f32 v9, v21, v21
    v_fmac_f32 v8, v22, v22
    v_fmac_f32 v9, v23, v23
    v_fmac_f32 v8, v24, v24
    v_fmac_f32 v9, v25, v25
    v_fmac_f32 v8, v26, v26
    v_fmac_f32 v9, v27, v27
    v_fmac_f32 v8, v28, v28
    v_fmac_f32 v9, v29, v29
    v_fmac_f32 v8, v30, v30
    v_fmac_f32 v9, v31, v31
    v_add_f32 v8, v8, v9
    s_nop 1
    v_add_f32_dpp v8, v8, v8 row_ror:8 row_mask:0xf bank_mask:0xf
    s_nop 1
    v_add_f32_dpp v8, v8, v8 row_ror:4 row_mask:0xf bank_mask:0xf
    s_nop 1
    v_add_f32_dpp v8, v8, v8 row_ror:2 row_mask:0xf bank_mask:0xf
    s_nop 1
    v_add_f32_dpp v8, v8, v8 row_ror:1 row_mask:0xf bank_mask:0xf
    v_mov_b32 v9, v8
    s_nop 1
    v_permlane16_swap_b32 v8, v9
    s_nop 1
    v_add_f32 v8, v8, v9
    v_mov_b32 v9, v8
    s_nop 1
    v_permlane32_swap_b32 v8, v9
    s_nop 1
    v_add_f32 v8, v8, v9
    v_mov_b32 v9, 0x3727c5ac
    v_fmac_f32 v9, 0x3a97b426, v8
    v_rsq_f32 v9, v9
    s_nop 0
    v_mul_f32 v16, v16, v9
    v_mul_f32 v17, v17, v9
    v_mul_f32 v18, v18, v9
    v_mul_f32 v19, v19, v9
    v_mul_f32 v20, v20, v9
    v_mul_f32 v21, v21, v9
    v_mul_f32 v22, v22, v9
    v_mul_f32 v23, v23, v9
    v_mul_f32 v24, v24, v9
    v_mul_f32 v25, v25, v9
    v_mul_f32 v26, v26, v9
    v_mul_f32 v27, v27, v9
    v_mul_f32 v28, v28, v9
    v_mul_f32 v29, v29, v9
    v_mul_f32 v30, v30, v9
    v_mul_f32 v31, v31, v9
    v_cvt_pk_bf16_f32 v8, v16, v17
    v_cvt_pk_bf16_f32 v9, v18, v19
    v_cvt_pk_bf16_f32 v10, v20, v21
    v_cvt_pk_bf16_f32 v11, v22, v23
    v_cvt_pk_bf16_f32 v12, v24, v25
    v_cvt_pk_bf16_f32 v13, v26, v27
    v_cvt_pk_bf16_f32 v14, v28, v29
    v_cvt_pk_bf16_f32 v15, v30, v31
    buffer_store_dwordx4 v[8:11], v3, s[16:19], 0 offen sc1
    s_mov_b64 exec, s[54:55]
    s_mov_b32 s52, 2097152
    buffer_store_dwordx4 v[12:15], v3, s[16:19], s52 offen sc1
    s_mov_b64 exec, s[56:57]
    s_waitcnt vmcnt(0)
    s_setprio 0
    s_barrier
    s_cmp_lg_u32 s20, 0
    s_cbranch_scc1 k2_kernel_g_noflag
    s_lshr_b32 s30, s2, 3
    s_lshl_b32 s30, s30, 7
    v_mov_b32 v2, s30
    v_mov_b32 v3, 1
    s_mov_b64 exec, 1
    buffer_atomic_add v3, v2, s[12:15], 0 offen sc1
    s_mov_b64 exec, -1
k2_kernel_g_noflag:
    s_cmp_lg_u32 s24, 7
    s_cbranch_scc1 k2_kernel_g_gemm
    s_branch k2_kernel_exit
k2_kernel_g_gemm:
    s_lshr_b32 s22, s21, 1
    s_and_b32 s29, s21, 1
    s_cmp_ge_u32 s20, 4
    s_cbranch_scc0 k2_kernel_g_cons
    s_mov_b32 s8, s42
    s_mov_b32 s9, s43
    s_mov_b32 s10, 8388608
    s_mov_b32 s11, 0x20000
    s_add_u32 s16, s46, 16777216
    s_addc_u32 s17, s47, 0
    s_mov_b32 s18, 3670016
    s_mov_b32 s19, 0x20000
    s_setprio 3
    s_waitcnt vmcnt(0)
    s_setprio 0
    s_barrier
    s_setprio 3
    s_add_u32 m0, s64, s61
    s_nop 0
    buffer_load_dwordx4 v44, s[72:75], s66 offen offset:0 lds
    buffer_load_dwordx4 v45, s[72:75], s66 offen offset:1024 lds
    buffer_load_dwordx4 v46, s[72:75], s66 offen offset:2048 lds
    buffer_load_dwordx4 v47, s[72:75], s66 offen offset:3072 lds
    s_add_u32 s66, s66, 221184
    s_mov_b32 s67, s62
    s_mov_b32 s62, s63
    s_mov_b32 s63, s64
    s_mov_b32 s64, s67
    s_mov_b32 s69, 7
k2_kernel_g_l1:
    s_waitcnt vmcnt(4)
    s_setprio 0
    s_barrier
    s_setprio 3
    s_add_u32 m0, s64, s61
    s_nop 0
    buffer_load_dwordx4 v44, s[72:75], s66 offen offset:0 lds
    buffer_load_dwordx4 v45, s[72:75], s66 offen offset:1024 lds
    buffer_load_dwordx4 v46, s[72:75], s66 offen offset:2048 lds
    buffer_load_dwordx4 v47, s[72:75], s66 offen offset:3072 lds
    s_add_u32 s66, s66, 221184
    s_mov_b32 s67, s62
    s_mov_b32 s62, s63
    s_mov_b32 s63, s64
    s_mov_b32 s64, s67
    s_sub_u32 s69, s69, 1
    s_cmp_lg_u32 s69, 0
    s_cbranch_scc1 k2_kernel_g_l1
    s_mov_b32 s65, 0
    s_mov_b32 s66, 0
    s_waitcnt vmcnt(4)
    s_cmp_lg_u32 s20, 4
    s_cbranch_scc1 k2_kernel_g_nopoll
    v_and_b32 v2, 31, v1
    v_lshlrev_b32 v2, 7, v2
    s_movk_i32 s32, 0x4000
k2_kernel_g_poll:
    buffer_load_dword v3, v2, s[12:15], 0 offen sc1
    s_waitcnt vmcnt(0)
    v_cmp_le_u32 vcc, 8, v3
    s_nop 3
    s_cmp_eq_u64 vcc, -1
    s_cbranch_scc1 k2_kernel_g_polled
    s_sub_u32 s32, s32, 1
    s_cmp_eq_u32 s32, 0
    s_cbranch_scc1 k2_kernel_g_polled
    s_sleep 2
    s_branch k2_kernel_g_poll
k2_kernel_g_polled:
k2_kernel_g_nopoll:
    s_setprio 0
    s_barrier
    s_setprio 3
    s_add_u32 m0, s64, s61
    s_add_u32 s65, s65, 128
    buffer_load_dwordx4 v48, s[16:19], s66 offen offset:0 sc1 lds
    buffer_load_dwordx4 v48, s[16:19], s66 offen offset:1024 sc1 lds
    buffer_load_dwordx4 v48, s[16:19], s66 offen offset:2048 sc1 lds
    buffer_load_dwordx4 v48, s[16:19], s66 offen offset:3072 sc1 lds
    s_add_u32 s66, s66, 16384
    s_mov_b32 s67, s62
    s_mov_b32 s62, s63
    s_mov_b32 s63, s64
    s_mov_b32 s64, s67
    s_waitcnt vmcnt(4)
    s_setprio 0
    s_barrier
    s_setprio 3
    s_add_u32 m0, s64, s61
    s_add_u32 s65, s65, 128
    buffer_load_dwordx4 v48, s[16:19], s66 offen offset:0 sc1 lds
    buffer_load_dwordx4 v48, s[16:19], s66 offen offset:1024 sc1 lds
    buffer_load_dwordx4 v48, s[16:19], s66 offen offset:2048 sc1 lds
    buffer_load_dwordx4 v48, s[16:19], s66 offen offset:3072 sc1 lds
    s_add_u32 s66, s66, 16384
    s_mov_b32 s67, s62
    s_mov_b32 s62, s63
    s_mov_b32 s63, s64
    s_mov_b32 s64, s67
    s_mov_b32 s69, 30
k2_kernel_g_l2:
    s_waitcnt vmcnt(4)
    s_setprio 0
    s_barrier
    s_setprio 3
    s_add_u32 m0, s64, s61
    s_add_u32 s65, s65, 128
    buffer_load_dwordx4 v48, s[16:19], s66 offen offset:0 sc1 lds
    buffer_load_dwordx4 v48, s[16:19], s66 offen offset:1024 sc1 lds
    buffer_load_dwordx4 v48, s[16:19], s66 offen offset:2048 sc1 lds
    buffer_load_dwordx4 v48, s[16:19], s66 offen offset:3072 sc1 lds
    s_add_u32 s66, s66, 16384
    s_mov_b32 s67, s62
    s_mov_b32 s62, s63
    s_mov_b32 s63, s64
    s_mov_b32 s64, s67
    s_sub_u32 s69, s69, 1
    s_cmp_lg_u32 s69, 0
    s_cbranch_scc1 k2_kernel_g_l2
    s_waitcnt vmcnt(4)
    s_setprio 0
    s_barrier
    s_setprio 3
    s_mov_b32 s67, s62
    s_mov_b32 s62, s63
    s_mov_b32 s63, s64
    s_mov_b32 s64, s67
    s_waitcnt vmcnt(0)
    s_setprio 0
    s_barrier
    s_setprio 3
    s_mov_b32 s67, s62
    s_mov_b32 s62, s63
    s_mov_b32 s63, s64
    s_mov_b32 s64, s67
    s_add_u32 s4, s46, 25165824
    s_addc_u32 s5, s47, 0
    s_mov_b32 s6, 3670016
    s_mov_b32 s7, 0x20000
    s_add_u32 s8, s46, 31457280
    s_addc_u32 s9, s47, 0
    s_mov_b32 s10, 2236416
    s_mov_b32 s11, 0x20000
    s_add_u32 s16, s46, 20971520
    s_addc_u32 s17, s47, 0
    s_mov_b32 s18, 3145728
    s_mov_b32 s19, 0x20000
    s_add_u32 s12, s46, 30408704
    s_addc_u32 s13, s47, 0
    s_mov_b32 s14, 16384
    s_mov_b32 s15, 0x20000
    s_mul_i32 s28, s24, 192
    s_mul_i32 s29, s23, 114688
    s_lshl_b32 s30, s21, 11
    s_add_u32 s29, s29, s30
    v_lshlrev_b32 v2, 4, v1
    v_add_u32 v10, s29, v2
    v_lshrrev_b32 v2, 3, v1
    v_and_b32 v3, 7, v1
    s_lshl_b32 s29, s21, 4
    s_add_u32 s29, s29, 0
    v_add_u32 v4, s29, v2
    v_bfe_u32 v5, v4, 1, 3
    v_xor_b32 v5, v5, v3
    v_lshrrev_b32 v6, 5, v4
    s_lshl_b32 s29, s23, 1
    v_add_u32 v6, s29, v6
    s_movk_i32 s29, 1536
    v_mul_lo_u32 v6, v6, s29
    v_and_b32 v7, 31, v4
    v_mul_u32_u24 v7, 48, v7
    v_add_u32 v6, v6, v7
    v_add_u32 v7, 0, v5
    v_mul_u32_u24 v8, 21846, v7
    v_lshrrev_b32 v8, 16, v8
    v_mul_u32_u24 v9, 3, v8
    v_sub_u32 v9, v7, v9
    s_mov_b32 s29, 98304
    v_mul_lo_u32 v8, v8, s29
    v_lshl_add_u32 v8, v9, 4, v8
    v_add_u32 v8, v8, v6
    v_mov_b32 v12, v8
    v_add_u32 v7, 8, v5
    v_mul_u32_u24 v8, 21846, v7
    v_lshrrev_b32 v8, 16, v8
    v_mul_u32_u24 v9, 3, v8
    v_sub_u32 v9, v7, v9
    s_mov_b32 s29, 98304
    v_mul_lo_u32 v8, v8, s29
    v_lshl_add_u32 v8, v9, 4, v8
    v_add_u32 v8, v8, v6
    v_mov_b32 v14, v8
    v_add_u32 v7, 16, v5
    v_mul_u32_u24 v8, 21846, v7
    v_lshrrev_b32 v8, 16, v8
    v_mul_u32_u24 v9, 3, v8
    v_sub_u32 v9, v7, v9
    s_mov_b32 s29, 98304
    v_mul_lo_u32 v8, v8, s29
    v_lshl_add_u32 v8, v9, 4, v8
    v_add_u32 v8, v8, v6
    v_mov_b32 v16, v8
    s_lshl_b32 s29, s21, 4
    s_add_u32 s29, s29, 8
    v_add_u32 v4, s29, v2
    v_bfe_u32 v5, v4, 1, 3
    v_xor_b32 v5, v5, v3
    v_lshrrev_b32 v6, 5, v4
    s_lshl_b32 s29, s23, 1
    v_add_u32 v6, s29, v6
    s_movk_i32 s29, 1536
    v_mul_lo_u32 v6, v6, s29
    v_and_b32 v7, 31, v4
    v_mul_u32_u24 v7, 48, v7
    v_add_u32 v6, v6, v7
    v_add_u32 v7, 0, v5
    v_mul_u32_u24 v8, 21846, v7
    v_lshrrev_b32 v8, 16, v8
    v_mul_u32_u24 v9, 3, v8
    v_sub_u32 v9, v7, v9
    s_mov_b32 s29, 98304
    v_mul_lo_u32 v8, v8, s29
    v_lshl_add_u32 v8, v9, 4, v8
    v_add_u32 v8, v8, v6
    v_mov_b32 v13, v8
    v_add_u32 v7, 8, v5
    v_mul_u32_u24 v8, 21846, v7
    v_lshrrev_b32 v8, 16, v8
    v_mul_u32_u24 v9, 3, v8
    v_sub_u32 v9, v7, v9
    s_mov_b32 s29, 98304
    v_mul_lo_u32 v8, v8, s29
    v_lshl_add_u32 v8, v9, 4, v8
    v_add_u32 v8, v8, v6
    v_mov_b32 v15, v8
    v_add_u32 v7, 16, v5
    v_mul_u32_u24 v8, 21846, v7
    v_lshrrev_b32 v8, 16, v8
    v_mul_u32_u24 v9, 3, v8
    v_sub_u32 v9, v7, v9
    s_mov_b32 s29, 98304
    v_mul_lo_u32 v8, v8, s29
    v_lshl_add_u32 v8, v9, 4, v8
    v_add_u32 v8, v8, v6
    v_mov_b32 v17, v8
    s_mul_i32 s29, s24, 319488
    s_mul_i32 s30, s21, 3072
    s_add_u32 s29, s29, s30
    v_lshlrev_b32 v2, 4, v1
    v_add_u32 v18, s29, v2
    s_lshl_b32 s31, s21, 11
    s_mul_i32 s30, s21, 3072
    s_mov_b32 s62, 0
    s_mov_b32 s63, 20480
    s_mov_b32 s64, 40960
    s_mov_b32 s65, 61440
    s_setprio 0
    s_barrier
    s_setprio 3
    s_add_u32 m0, s30, 32768
    s_mov_b32 s29, 0
    buffer_load_dwordx4 v18, s[8:11], s29 offen offset:0 lds
    buffer_load_dwordx4 v18, s[8:11], s29 offen offset:1024 lds
    buffer_load_dwordx4 v18, s[8:11], s29 offen offset:2048 lds
    s_add_u32 m0, s30, 45056
    s_mov_b32 s29, 12288
    buffer_load_dwordx4 v18, s[8:11], s29 offen offset:0 lds
    buffer_load_dwordx4 v18, s[8:11], s29 offen offset:1024 lds
    buffer_load_dwordx4 v18, s[8:11], s29 offen offset:2048 lds
    s_add_u32 m0, s30, 57344
    s_mov_b32 s29, 24576
    buffer_load_dwordx4 v18, s[8:11], s29 offen offset:0 lds
    buffer_load_dwordx4 v18, s[8:11], s29 offen offset:1024 lds
    buffer_load_dwordx4 v18, s[8:11], s29 offen offset:2048 lds
    s_lshl_b32 s29, s23, 7
    s_add_u32 s36, s29, 4096
    s_cmp_lg_u32 s20, 4
    s_cbranch_scc1 k2_kernel_pu_np
    v_mov_b32 v2, s36
    s_mov_b32 s32, 0x8000
k2_kernel_pu_p:
    buffer_load_dword v3, v2, s[12:15], 0 offen sc1
    s_waitcnt vmcnt(0)
    v_readfirstlane_b32 s33, v3
    s_nop 3
    s_cmp_ge_u32 s33, 7
    s_cbranch_scc1 k2_kernel_pu_np
    s_sub_u32 s32, s32, 1
    s_cmp_eq_u32 s32, 0
    s_cbranch_scc1 k2_kernel_pu_np
    s_sleep 2
    s_branch k2_kernel_pu_p
k2_kernel_pu_np:
    s_setprio 0
    s_barrier
    s_setprio 3
    s_add_u32 m0, s31, 0
    s_mov_b32 s29, 0
    buffer_load_dwordx4 v10, s[4:7], s29 offen offset:0 sc1 lds
    buffer_load_dwordx4 v10, s[4:7], s29 offen offset:1024 sc1 lds
    s_add_u32 m0, s31, 8192
    s_mov_b32 s29, 8192
    buffer_load_dwordx4 v10, s[4:7], s29 offen offset:0 sc1 lds
    buffer_load_dwordx4 v10, s[4:7], s29 offen offset:1024 sc1 lds
    s_add_u32 m0, s31, 16384
    s_mov_b32 s29, 16384
    buffer_load_dwordx4 v10, s[4:7], s29 offen offset:0 sc1 lds
    buffer_load_dwordx4 v10, s[4:7], s29 offen offset:1024 sc1 lds
    s_waitcnt vmcnt(4)
    s_setprio 0
    s_barrier
    s_setprio 3
    s_add_u32 m0, s31, 24576
    s_mov_b32 s29, 24576
    buffer_load_dwordx4 v10, s[4:7], s29 offen offset:0 sc1 lds
    buffer_load_dwordx4 v10, s[4:7], s29 offen offset:1024 sc1 lds
    s_add_u32 m0, s30, 69632
    s_mov_b32 s29, 36864
    buffer_load_dwordx4 v18, s[8:11], s29 offen offset:0 lds
    buffer_load_dwordx4 v18, s[8:11], s29 offen offset:1024 lds
    buffer_load_dwordx4 v18, s[8:11], s29 offen offset:2048 lds
    s_mov_b32 s70, s62
    s_mov_b32 s62, s63
    s_mov_b32 s63, s64
    s_mov_b32 s64, s65
    s_mov_b32 s65, s70
    s_waitcnt vmcnt(7)
    s_setprio 0
    s_barrier
    s_setprio 3
    s_add_u32 m0, s31, 0
    s_mov_b32 s29, 32768
    buffer_load_dwordx4 v10, s[4:7], s29 offen offset:0 sc1 lds
    buffer_load_dwordx4 v10, s[4:7], s29 offen offset:1024 sc1 lds
    s_add_u32 m0, s30, 32768
    s_mov_b32 s29, 49152
    buffer_load_dwordx4 v18, s[8:11], s29 offen offset:0 lds
    buffer_load_dwordx4 v18, s[8:11], s29 offen offset:1024 lds
    buffer_load_dwordx4 v18, s[8:11], s29 offen offset:2048 lds
    s_mov_b32 s70, s62
    s_mov_b32 s62, s63
    s_mov_b32 s63, s64
    s_mov_b32 s64, s65
    s_mov_b32 s65, s70
    s_waitcnt vmcnt(10)
    s_setprio 0
    s_barrier
    s_setprio 3
    s_add_u32 m0, s31, 8192
    s_mov_b32 s29, 40960
    buffer_load_dwordx4 v10, s[4:7], s29 offen offset:0 sc1 lds
    buffer_load_dwordx4 v10, s[4:7], s29 offen offset:1024 sc1 lds
    s_add_u32 m0, s30, 45056
    s_mov_b32 s29, 61440
    buffer_load_dwordx4 v18, s[8:11], s29 offen offset:0 lds
    buffer_load_dwordx4 v18, s[8:11], s29 offen offset:1024 lds
    buffer_load_dwordx4 v18, s[8:11], s29 offen offset:2048 lds
    s_mov_b32 s70, s62
    s_mov_b32 s62, s63
    s_mov_b32 s63, s64
    s_mov_b32 s64, s65
    s_mov_b32 s65, s70
    s_waitcnt vmcnt(10)
    s_setprio 0
    s_barrier
    s_setprio 3
    s_add_u32 m0, s31, 16384
    s_mov_b32 s29, 49152
    buffer_load_dwordx4 v10, s[4:7], s29 offen offset:0 sc1 lds
    buffer_load_dwordx4 v10, s[4:7], s29 offen offset:1024 sc1 lds
    s_add_u32 m0, s30, 57344
    s_mov_b32 s29, 73728
    buffer_load_dwordx4 v18, s[8:11], s29 offen offset:0 lds
    buffer_load_dwordx4 v18, s[8:11], s29 offen offset:1024 lds
    buffer_load_dwordx4 v18, s[8:11], s29 offen offset:2048 lds
    s_mov_b32 s70, s62
    s_mov_b32 s62, s63
    s_mov_b32 s63, s64
    s_mov_b32 s64, s65
    s_mov_b32 s65, s70
    s_waitcnt vmcnt(10)
    s_setprio 0
    s_barrier
    s_setprio 3
    s_add_u32 m0, s31, 24576
    s_mov_b32 s29, 57344
    buffer_load_dwordx4 v10, s[4:7], s29 offen offset:0 sc1 lds
    buffer_load_dwordx4 v10, s[4:7], s29 offen offset:1024 sc1 lds
    s_add_u32 m0, s30, 69632
    s_mov_b32 s29, 86016
    buffer_load_dwordx4 v18, s[8:11], s29 offen offset:0 lds
    buffer_load_dwordx4 v18, s[8:11], s29 offen offset:1024 lds
    buffer_load_dwordx4 v18, s[8:11], s29 offen offset:2048 lds
    s_mov_b32 s70, s62
    s_mov_b32 s62, s63
    s_mov_b32 s63, s64
    s_mov_b32 s64, s65
    s_mov_b32 s65, s70
    s_waitcnt vmcnt(10)
    s_setprio 0
    s_barrier
    s_setprio 3
    s_add_u32 m0, s31, 0
    s_mov_b32 s29, 65536
    buffer_load_dwordx4 v10, s[4:7], s29 offen offset:0 sc1 lds
    buffer_load_dwordx4 v10, s[4:7], s29 offen offset:1024 sc1 lds
    s_add_u32 m0, s30, 32768
    s_mov_b32 s29, 98304
    buffer_load_dwordx4 v18, s[8:11], s29 offen offset:0 lds
    buffer_load_dwordx4 v18, s[8:11], s29 offen offset:1024 lds
    buffer_load_dwordx4 v18, s[8:11], s29 offen offset:2048 lds
    s_mov_b32 s70, s62
    s_mov_b32 s62, s63
    s_mov_b32 s63, s64
    s_mov_b32 s64, s65
    s_mov_b32 s65, s70
    s_waitcnt vmcnt(10)
    s_setprio 0
    s_barrier
    s_setprio 3
    s_add_u32 m0, s31, 8192
    s_mov_b32 s29, 73728
    buffer_load_dwordx4 v10, s[4:7], s29 offen offset:0 sc1 lds
    buffer_load_dwordx4 v10, s[4:7], s29 offen offset:1024 sc1 lds
    s_add_u32 m0, s30, 45056
    s_mov_b32 s29, 110592
    buffer_load_dwordx4 v18, s[8:11], s29 offen offset:0 lds
    buffer_load_dwordx4 v18, s[8:11], s29 offen offset:1024 lds
    buffer_load_dwordx4 v18, s[8:11], s29 offen offset:2048 lds
    s_mov_b32 s70, s62
    s_mov_b32 s62, s63
    s_mov_b32 s63, s64
    s_mov_b32 s64, s65
    s_mov_b32 s65, s70
    s_waitcnt vmcnt(10)
    s_setprio 0
    s_barrier
    s_setprio 3
    s_add_u32 m0, s31, 16384
    s_mov_b32 s29, 81920
    buffer_load_dwordx4 v10, s[4:7], s29 offen offset:0 sc1 lds
    buffer_load_dwordx4 v10, s[4:7], s29 offen offset:1024 sc1 lds
    s_add_u32 m0, s30, 57344
    s_mov_b32 s29, 122880
    buffer_load_dwordx4 v18, s[8:11], s29 offen offset:0 lds
    buffer_load_dwordx4 v18, s[8:11], s29 offen offset:1024 lds
    buffer_load_dwordx4 v18, s[8:11], s29 offen offset:2048 lds
    s_mov_b32 s70, s62
    s_mov_b32 s62, s63
    s_mov_b32 s63, s64
    s_mov_b32 s64, s65
    s_mov_b32 s65, s70
    s_waitcnt vmcnt(10)
    s_setprio 0
    s_barrier
    s_setprio 3
    s_add_u32 m0, s31, 24576
    s_mov_b32 s29, 90112
    buffer_load_dwordx4 v10, s[4:7], s29 offen offset:0 sc1 lds
    buffer_load_dwordx4 v10, s[4:7], s29 offen offset:1024 sc1 lds
    s_add_u32 m0, s30, 69632
    s_mov_b32 s29, 135168
    buffer_load_dwordx4 v18, s[8:11], s29 offen offset:0 lds
    buffer_load_dwordx4 v18, s[8:11], s29 offen offset:1024 lds
    buffer_load_dwordx4 v18, s[8:11], s29 offen offset:2048 lds
    s_mov_b32 s70, s62
    s_mov_b32 s62, s63
    s_mov_b32 s63, s64
    s_mov_b32 s64, s65
    s_mov_b32 s65, s70
    s_waitcnt vmcnt(10)
    s_setprio 0
    s_barrier
    s_setprio 3
    s_add_u32 m0, s31, 0
    s_mov_b32 s29, 98304
    buffer_load_dwordx4 v10, s[4:7], s29 offen offset:0 sc1 lds
    buffer_load_dwordx4 v10, s[4:7], s29 offen offset:1024 sc1 lds
    s_add_u32 m0, s30, 32768
    s_mov_b32 s29, 147456
    buffer_load_dwordx4 v18, s[8:11], s29 offen offset:0 lds
    buffer_load_dwordx4 v18, s[8:11], s29 offen offset:1024 lds
    buffer_load_dwordx4 v18, s[8:11], s29 offen offset:2048 lds
    s_mov_b32 s70, s62
    s_mov_b32 s62, s63
    s_mov_b32 s63, s64
    s_mov_b32 s64, s65
    s_mov_b32 s65, s70
    s_waitcnt vmcnt(10)
    s_setprio 0
    s_barrier
    s_setprio 3
    s_add_u32 m0, s31, 8192
    s_mov_b32 s29, 106496
    buffer_load_dwordx4 v10, s[4:7], s29 offen offset:0 sc1 lds
    buffer_load_dwordx4 v10, s[4:7], s29 offen offset:1024 sc1 lds
    s_add_u32 m0, s30, 45056
    s_mov_b32 s29, 159744
    buffer_load_dwordx4 v18, s[8:11], s29 offen offset:0 lds
    buffer_load_dwordx4 v18, s[8:11], s29 offen offset:1024 lds
    buffer_load_dwordx4 v18, s[8:11], s29 offen offset:2048 lds
    s_mov_b32 s70, s62
    s_mov_b32 s62, s63
    s_mov_b32 s63, s64
    s_mov_b32 s64, s65
    s_mov_b32 s65, s70
    s_waitcnt vmcnt(10)
    s_setprio 0
    s_barrier
    s_setprio 3
    s_add_u32 m0, s30, 57344
    s_mov_b32 s29, 172032
    buffer_load_dwordx4 v18, s[8:11], s29 offen offset:0 lds
    buffer_load_dwordx4 v18, s[8:11], s29 offen offset:1024 lds
    buffer_load_dwordx4 v18, s[8:11], s29 offen offset:2048 lds
    s_mov_b32 s70, s62
    s_mov_b32 s62, s63
    s_mov_b32 s63, s64
    s_mov_b32 s64, s65
    s_mov_b32 s65, s70
    s_waitcnt vmcnt(8)
    s_setprio 0
    s_barrier
    s_setprio 3
    s_add_u32 m0, s30, 69632
    s_mov_b32 s29, 184320
    buffer_load_dwordx4 v18, s[8:11], s29 offen offset:0 lds
    buffer_load_dwordx4 v18, s[8:11], s29 offen offset:1024 lds
    buffer_load_dwordx4 v18, s[8:11], s29 offen offset:2048 lds
    s_mov_b32 s70, s62
    s_mov_b32 s62, s63
    s_mov_b32 s63, s64
    s_mov_b32 s64, s65
    s_mov_b32 s65, s70
    s_waitcnt vmcnt(6)
    s_setprio 0
    s_barrier
    s_setprio 3
    s_add_u32 m0, s30, 32768
    s_mov_b32 s29, 196608
    buffer_load_dwordx4 v18, s[8:11], s29 offen offset:0 lds
    buffer_load_dwordx4 v18, s[8:11], s29 offen offset:1024 lds
    buffer_load_dwordx4 v18, s[8:11], s29 offen offset:2048 lds
    s_mov_b32 s70, s62
    s_mov_b32 s62, s63
    s_mov_b32 s63, s64
    s_mov_b32 s64, s65
    s_mov_b32 s65, s70
    s_lshl_b32 s29, s23, 7
    s_add_u32 s36, s29, 8192
    s_cmp_lg_u32 s20, 4
    s_cbranch_scc1 k2_kernel_po_np
    v_mov_b32 v2, s36
    s_mov_b32 s32, 0x8000
k2_kernel_po_p:
    buffer_load_dword v3, v2, s[12:15], 0 offen sc1
    s_waitcnt vmcnt(0)
    v_readfirstlane_b32 s33, v3
    s_nop 3
    s_cmp_ge_u32 s33, 64
    s_cbranch_scc1 k2_kernel_po_np
    s_sub_u32 s32, s32, 1
    s_cmp_eq_u32 s32, 0
    s_cbranch_scc1 k2_kernel_po_np
    s_sleep 2
    s_branch k2_kernel_po_p
k2_kernel_po_np:
    s_setprio 0
    s_barrier
    s_setprio 3
    s_add_u32 m0, s31, 16384
    s_mov_b32 s29, 0
    buffer_load_dwordx4 v12, s[16:19], s29 offen sc1 lds
    s_add_u32 m0, m0, 1024
    s_nop 0
    buffer_load_dwordx4 v13, s[16:19], s29 offen sc1 lds
    s_add_u32 m0, s31, 24576
    s_mov_b32 s29, 0
    buffer_load_dwordx4 v14, s[16:19], s29 offen sc1 lds
    s_add_u32 m0, m0, 1024
    s_nop 0
    buffer_load_dwordx4 v15, s[16:19], s29 offen sc1 lds
    s_add_u32 m0, s31, 0
    s_mov_b32 s29, 0
    buffer_load_dwordx4 v16, s[16:19], s29 offen sc1 lds
    s_add_u32 m0, m0, 1024
    s_nop 0
    buffer_load_dwordx4 v17, s[16:19], s29 offen sc1 lds
    s_waitcnt vmcnt(4)
    s_setprio 0
    s_barrier
    s_setprio 3
    s_add_u32 m0, s31, 8192
    s_mov_b32 s29, 786432
    buffer_load_dwordx4 v12, s[16:19], s29 offen sc1 lds
    s_add_u32 m0, m0, 1024
    s_nop 0
    buffer_load_dwordx4 v13, s[16:19], s29 offen sc1 lds
    s_add_u32 m0, s30, 45056
    s_mov_b32 s29, 208896
    buffer_load_dwordx4 v18, s[8:11], s29 offen offset:0 lds
    buffer_load_dwordx4 v18, s[8:11], s29 offen offset:1024 lds
    buffer_load_dwordx4 v18, s[8:11], s29 offen offset:2048 lds
    s_mov_b32 s70, s62
    s_mov_b32 s62, s63
    s_mov_b32 s63, s64
    s_mov_b32 s64, s65
    s_mov_b32 s65, s70
    s_waitcnt vmcnt(7)
    s_setprio 0
    s_barrier
    s_setprio 3
    s_add_u32 m0, s31, 16384
    s_mov_b32 s29, 786432
    buffer_load_dwordx4 v14, s[16:19], s29 offen sc1 lds
    s_add_u32 m0, m0, 1024
    s_nop 0
    buffer_load_dwordx4 v15, s[16:19], s29 offen sc1 lds
    s_add_u32 m0, s30, 57344
    s_mov_b32 s29, 221184
    buffer_load_dwordx4 v18, s[8:11], s29 offen offset:0 lds
    buffer_load_dwordx4 v18, s[8:11], s29 offen offset:1024 lds
    buffer_load_dwordx4 v18, s[8:11], s29 offen offset:2048 lds
    s_mov_b32 s70, s62
    s_mov_b32 s62, s63
    s_mov_b32 s63, s64
    s_mov_b32 s64, s65
    s_mov_b32 s65, s70
    s_waitcnt vmcnt(10)
    s_setprio 0
    s_barrier
    s_setprio 3
    s_add_u32 m0, s31, 24576
    s_mov_b32 s29, 786432
    buffer_load_dwordx4 v16, s[16:19], s29 offen sc1 lds
    s_add_u32 m0, m0, 1024
    s_nop 0
    buffer_load_dwordx4 v17, s[16:19], s29 offen sc1 lds
    s_add_u32 m0, s30, 69632
    s_mov_b32 s29, 233472
    buffer_load_dwordx4 v18, s[8:11], s29 offen offset:0 lds
    buffer_load_dwordx4 v18, s[8:11], s29 offen offset:1024 lds
    buffer_load_dwordx4 v18, s[8:11], s29 offen offset:2048 lds
    s_mov_b32 s70, s62
    s_mov_b32 s62, s63
    s_mov_b32 s63, s64
    s_mov_b32 s64, s65
    s_mov_b32 s65, s70
    s_waitcnt vmcnt(10)
    s_setprio 0
    s_barrier
    s_setprio 3
    s_add_u32 m0, s31, 0
    s_mov_b32 s29, 1572864
    buffer_load_dwordx4 v12, s[16:19], s29 offen sc1 lds
    s_add_u32 m0, m0, 1024
    s_nop 0
    buffer_load_dwordx4 v13, s[16:19], s29 offen sc1 lds
    s_add_u32 m0, s30, 32768
    s_mov_b32 s29, 245760
    buffer_load_dwordx4 v18, s[8:11], s29 offen offset:0 lds
    buffer_load_dwordx4 v18, s[8:11], s29 offen offset:1024 lds
    buffer_load_dwordx4 v18, s[8:11], s29 offen offset:2048 lds
    s_mov_b32 s70, s62
    s_mov_b32 s62, s63
    s_mov_b32 s63, s64
    s_mov_b32 s64, s65
    s_mov_b32 s65, s70
    s_waitcnt vmcnt(10)
    s_setprio 0
    s_barrier
    s_setprio 3
    s_add_u32 m0, s31, 8192
    s_mov_b32 s29, 1572864
    buffer_load_dwordx4 v14, s[16:19], s29 offen sc1 lds
    s_add_u32 m0, m0, 1024
    s_nop 0
    buffer_load_dwordx4 v15, s[16:19], s29 offen sc1 lds
    s_add_u32 m0, s30, 45056
    s_mov_b32 s29, 258048
    buffer_load_dwordx4 v18, s[8:11], s29 offen offset:0 lds
    buffer_load_dwordx4 v18, s[8:11], s29 offen offset:1024 lds
    buffer_load_dwordx4 v18, s[8:11], s29 offen offset:2048 lds
    s_mov_b32 s70, s62
    s_mov_b32 s62, s63
    s_mov_b32 s63, s64
    s_mov_b32 s64, s65
    s_mov_b32 s65, s70
    s_waitcnt vmcnt(10)
    s_setprio 0
    s_barrier
    s_setprio 3
    s_add_u32 m0, s31, 16384
    s_mov_b32 s29, 1572864
    buffer_load_dwordx4 v16, s[16:19], s29 offen sc1 lds
    s_add_u32 m0, m0, 1024
    s_nop 0
    buffer_load_dwordx4 v17, s[16:19], s29 offen sc1 lds
    s_add_u32 m0, s30, 57344
    s_mov_b32 s29, 270336
    buffer_load_dwordx4 v18, s[8:11], s29 offen offset:0 lds
    buffer_load_dwordx4 v18, s[8:11], s29 offen offset:1024 lds
    buffer_load_dwordx4 v18, s[8:11], s29 offen offset:2048 lds
    s_mov_b32 s70, s62
    s_mov_b32 s62, s63
    s_mov_b32 s63, s64
    s_mov_b32 s64, s65
    s_mov_b32 s65, s70
    s_waitcnt vmcnt(10)
    s_setprio 0
    s_barrier
    s_setprio 3
    s_add_u32 m0, s31, 24576
    s_mov_b32 s29, 2359296
    buffer_load_dwordx4 v12, s[16:19], s29 offen sc1 lds
    s_add_u32 m0, m0, 1024
    s_nop 0
    buffer_load_dwordx4 v13, s[16:19], s29 offen sc1 lds
    s_add_u32 m0, s30, 69632
    s_mov_b32 s29, 282624
    buffer_load_dwordx4 v18, s[8:11], s29 offen offset:0 lds
    buffer_load_dwordx4 v18, s[8:11], s29 offen offset:1024 lds
    buffer_load_dwordx4 v18, s[8:11], s29 offen offset:2048 lds
    s_mov_b32 s70, s62
    s_mov_b32 s62, s63
    s_mov_b32 s63, s64
    s_mov_b32 s64, s65
    s_mov_b32 s65, s70
    s_waitcnt vmcnt(10)
    s_setprio 0
    s_barrier
    s_setprio 3
    s_add_u32 m0, s31, 0
    s_mov_b32 s29, 2359296
    buffer_load_dwordx4 v14, s[16:19], s29 offen sc1 lds
    s_add_u32 m0, m0, 1024
    s_nop 0
    buffer_load_dwordx4 v15, s[16:19], s29 offen sc1 lds
    s_add_u32 m0, s30, 32768
    s_mov_b32 s29, 294912
    buffer_load_dwordx4 v18, s[8:11], s29 offen offset:0 lds
    buffer_load_dwordx4 v18, s[8:11], s29 offen offset:1024 lds
    buffer_load_dwordx4 v18, s[8:11], s29 offen offset:2048 lds
    s_mov_b32 s70, s62
    s_mov_b32 s62, s63
    s_mov_b32 s63, s64
    s_mov_b32 s64, s65
    s_mov_b32 s65, s70
    s_waitcnt vmcnt(10)
    s_setprio 0
    s_barrier
    s_setprio 3
    s_add_u32 m0, s31, 8192
    s_mov_b32 s29, 2359296
    buffer_load_dwordx4 v16, s[16:19], s29 offen sc1 lds
    s_add_u32 m0, m0, 1024
    s_nop 0
    buffer_load_dwordx4 v17, s[16:19], s29 offen sc1 lds
    s_add_u32 m0, s30, 45056
    s_mov_b32 s29, 307200
    buffer_load_dwordx4 v18, s[8:11], s29 offen offset:0 lds
    buffer_load_dwordx4 v18, s[8:11], s29 offen offset:1024 lds
    buffer_load_dwordx4 v18, s[8:11], s29 offen offset:2048 lds
    s_mov_b32 s70, s62
    s_mov_b32 s62, s63
    s_mov_b32 s63, s64
    s_mov_b32 s64, s65
    s_mov_b32 s65, s70
    s_waitcnt vmcnt(10)
    s_setprio 0
    s_barrier
    s_setprio 3
    s_mov_b32 s70, s62
    s_mov_b32 s62, s63
    s_mov_b32 s63, s64
    s_mov_b32 s64, s65
    s_mov_b32 s65, s70
    s_waitcnt vmcnt(5)
    s_setprio 0
    s_barrier
    s_setprio 3
    s_mov_b32 s70, s62
    s_mov_b32 s62, s63
    s_mov_b32 s63, s64
    s_mov_b32 s64, s65
    s_mov_b32 s65, s70
    s_waitcnt vmcnt(0)
    s_setprio 0
    s_barrier
    s_setprio 3
    s_mov_b32 s70, s62
    s_mov_b32 s62, s63
    s_mov_b32 s63, s64
    s_mov_b32 s64, s65
    s_mov_b32 s65, s70
    s_branch k2_kernel_exit
k2_kernel_g_cons:
    v_mov_b32 v10, v40
    v_mov_b32 v11, v41
    v_mov_b32 v12, v42
    v_mov_b32 v13, v43
    s_mov_b32 s8, s42
    s_mov_b32 s9, s43
    s_mov_b32 s10, 8388608
    s_mov_b32 s11, 0x20000
    v_and_b32 v2, 31, v1
    s_mul_i32 s67, s22, 32
    v_add_u32 v2, s67, v2
    v_lshlrev_b32 v2, 7, v2
    v_lshrrev_b32 v3, 5, v1
    v_bfe_u32 v4, v1, 1, 3
    v_or_b32 v5, 0, v3
    v_xor_b32 v5, v5, v4
    v_lshl_add_u32 v16, v5, 4, v2
    v_or_b32 v5, 2, v3
    v_xor_b32 v5, v5, v4
    v_lshl_add_u32 v17, v5, 4, v2
    v_or_b32 v5, 4, v3
    v_xor_b32 v5, v5, v4
    v_lshl_add_u32 v18, v5, 4, v2
    v_or_b32 v5, 6, v3
    v_xor_b32 v5, v5, v4
    v_lshl_add_u32 v19, v5, 4, v2
    v_lshrrev_b32 v2, 5, v1
    v_bfe_u32 v3, v1, 2, 2
    v_lshl_add_u32 v4, v2, 3, v3
    v_lshlrev_b32 v4, 8, v4
    v_bfe_u32 v5, v1, 4, 1
    v_lshl_add_u32 v4, v5, 5, v4
    v_and_b32 v5, 1, v1
    v_lshl_add_u32 v4, v5, 4, v4
    v_bfe_u32 v5, v1, 1, 1
    v_lshl_add_u32 v4, v5, 3, v4
    v_add_u32 v4, 8192, v4
    s_mul_i32 s67, s29, 2
    s_add_u32 s68, s67, 0
    v_xor_b32 v5, s68, v3
    v_lshl_add_u32 v20, v5, 6, v4
    s_add_u32 s68, s67, 1
    v_xor_b32 v5, s68, v3
    v_lshl_add_u32 v21, v5, 6, v4
    v_mov_b32 v52, 0
    v_mov_b32 v53, 0
    v_mov_b32 v54, 0
    v_mov_b32 v55, 0
    v_mov_b32 v56, 0
    v_mov_b32 v57, 0
    v_mov_b32 v58, 0
    v_mov_b32 v59, 0
    v_mov_b32 v60, 0
    v_mov_b32 v61, 0
    v_mov_b32 v62, 0
    v_mov_b32 v63, 0
    v_mov_b32 v64, 0
    v_mov_b32 v65, 0
    v_mov_b32 v66, 0
    v_mov_b32 v67, 0
    v_mov_b32 v68, 0
    v_mov_b32 v69, 0
    v_mov_b32 v70, 0
    v_mov_b32 v71, 0
    v_mov_b32 v72, 0
    v_mov_b32 v73, 0
    v_mov_b32 v74, 0
    v_mov_b32 v75, 0
    v_mov_b32 v76, 0
    v_mov_b32 v77, 0
    v_mov_b32 v78, 0
    v_mov_b32 v79, 0
    v_mov_b32 v80, 0
    v_mov_b32 v81, 0
    v_mov_b32 v82, 0
    v_mov_b32 v83, 0
    v_mov_b32 v84, 0
    v_mov_b32 v85, 0
    v_mov_b32 v86, 0
    v_mov_b32 v87, 0
    v_mov_b32 v88, 0
    v_mov_b32 v89, 0
    v_mov_b32 v90, 0
    v_mov_b32 v91, 0
    v_mov_b32 v92, 0
    v_mov_b32 v93, 0
    v_mov_b32 v94, 0
    v_mov_b32 v95, 0
    v_mov_b32 v96, 0
    v_mov_b32 v97, 0
    v_mov_b32 v98, 0
    v_mov_b32 v99, 0
    v_mov_b32 v100, 0
    v_mov_b32 v101, 0
    v_mov_b32 v102, 0
    v_mov_b32 v103, 0
    v_mov_b32 v104, 0
    v_mov_b32 v105, 0
    v_mov_b32 v106, 0
    v_mov_b32 v107, 0
    v_mov_b32 v108, 0
    v_mov_b32 v109, 0
    v_mov_b32 v110, 0
    v_mov_b32 v111, 0
    v_mov_b32 v112, 0
    v_mov_b32 v113, 0
    v_mov_b32 v114, 0
    v_mov_b32 v115, 0
    s_mov_b32 s12, s38
    s_mov_b32 s13, s39
    s_mov_b32 s14, 4096
    s_mov_b32 s15, 0x20000
    s_add_u32 s16, s46, 25165824
    s_addc_u32 s17, s47, 0
    s_mov_b32 s18, 3670016
    s_mov_b32 s19, 0x20000
    v_and_b32 v2, 31, v1
    v_lshrrev_b32 v3, 5, v1
    s_lshl_b32 s33, s22, 5
    s_add_u32 s33, s33, s27
    v_add_u32 v2, s33, v2
    v_lshlrev_b32 v4, 1, v2
    buffer_load_ushort v9, v4, s[12:15], 0 offen
    s_mov_b32 s65, 256
    s_mov_b32 s69, 2
.p2align 6
k2_kernel_g_s1:
    s_waitcnt vmcnt(2)
    s_barrier
    s_setprio 3
    ds_read_b128 v[28:31], v16 offset:0
    ds_read_b64_tr_b16 v[32:33], v20 offset:0
    ds_read_b64_tr_b16 v[34:35], v20 offset:1024
    ds_read_b64_tr_b16 v[36:37], v21 offset:0
    ds_read_b64_tr_b16 v[38:39], v21 offset:1024
    s_waitcnt lgkmcnt(2)
    v_mfma_f32_32x32x16_bf16 v[52:67], v[32:35], v[28:31], v[52:67]
    ds_read_b128 v[40:43], v17 offset:0
    ds_read_b64_tr_b16 v[44:45], v20 offset:4096
    ds_read_b64_tr_b16 v[46:47], v20 offset:5120
    s_waitcnt lgkmcnt(3)
    v_mfma_f32_32x32x16_bf16 v[68:83], v[36:39], v[28:31], v[68:83]
    ds_read_b64_tr_b16 v[48:49], v21 offset:4096
    ds_read_b64_tr_b16 v[50:51], v21 offset:5120
    s_add_u32 m0, s60, 49152
    s_nop 0
    buffer_load_dwordx4 v10, s[4:7], s65 offen offset:0 lds
    buffer_load_dwordx4 v11, s[4:7], s65 offen offset:1024 lds
    s_add_u32 s65, s65, 128
    s_waitcnt lgkmcnt(2)
    v_mfma_f32_32x32x16_bf16 v[52:67], v[44:47], v[40:43], v[52:67]
    ds_read_b128 v[28:31], v18 offset:0
    ds_read_b64_tr_b16 v[32:33], v20 offset:8192
    ds_read_b64_tr_b16 v[34:35], v20 offset:9216
    s_waitcnt lgkmcnt(3)
    v_mfma_f32_32x32x16_bf16 v[68:83], v[48:51], v[40:43], v[68:83]
    ds_read_b64_tr_b16 v[36:37], v21 offset:8192
    ds_read_b64_tr_b16 v[38:39], v21 offset:9216
    s_waitcnt lgkmcnt(2)
    v_mfma_f32_32x32x16_bf16 v[52:67], v[32:35], v[28:31], v[52:67]
    ds_read_b128 v[40:43], v19 offset:0
    ds_read_b64_tr_b16 v[44:45], v20 offset:12288
    ds_read_b64_tr_b16 v[46:47], v20 offset:13312
    s_waitcnt lgkmcnt(3)
    v_mfma_f32_32x32x16_bf16 v[68:83], v[36:39], v[28:31], v[68:83]
    ds_read_b64_tr_b16 v[48:49], v21 offset:12288
    ds_read_b64_tr_b16 v[50:51], v21 offset:13312
    s_waitcnt lgkmcnt(2)
    v_mfma_f32_32x32x16_bf16 v[52:67], v[44:47], v[40:43], v[52:67]
    s_waitcnt lgkmcnt(0)
    v_mfma_f32_32x32x16_bf16 v[68:83], v[48:51], v[40:43], v[68:83]
    s_setprio 0
    s_waitcnt vmcnt(2)
    s_barrier
    s_setprio 3
    ds_read_b128 v[28:31], v16 offset:24576
    ds_read_b64_tr_b16 v[32:33], v20 offset:24576
    ds_read_b64_tr_b16 v[34:35], v20 offset:25600
    ds_read_b64_tr_b16 v[36:37], v21 offset:24576
    ds_read_b64_tr_b16 v[38:39], v21 offset:25600
    s_waitcnt lgkmcnt(2)
    v_mfma_f32_32x32x16_bf16 v[52:67], v[32:35], v[28:31], v[52:67]
    ds_read_b128 v[40:43], v17 offset:24576
    ds_read_b64_tr_b16 v[44:45], v20 offset:28672
    ds_read_b64_tr_b16 v[46:47], v20 offset:29696
    s_waitcnt lgkmcnt(3)
    v_mfma_f32_32x32x16_bf16 v[68:83], v[36:39], v[28:31], v[68:83]
    ds_read_b64_tr_b16 v[48:49], v21 offset:28672
    ds_read_b64_tr_b16 v[50:51], v21 offset:29696
    s_add_u32 m0, s60, 0
    s_nop 0
    buffer_load_dwordx4 v10, s[4:7], s65 offen offset:0 lds
    buffer_load_dwordx4 v11, s[4:7], s65 offen offset:1024 lds
    s_add_u32 s65, s65, 128
    s_waitcnt lgkmcnt(2)
    v_mfma_f32_32x32x16_bf16 v[52:67], v[44:47], v[40:43], v[52:67]
    ds_read_b128 v[28:31], v18 offset:24576
    ds_read_b64_tr_b16 v[32:33], v20 offset:32768
    ds_read_b64_tr_b16 v[34:35], v20 offset:33792
    s_waitcnt lgkmcnt(3)
    v_mfma_f32_32x32x16_bf16 v[68:83], v[48:51], v[40:43], v[68:83]
    ds_read_b64_tr_b16 v[36:37], v21 offset:32768
    ds_read_b64_tr_b16 v[38:39], v21 offset:33792
    s_waitcnt lgkmcnt(2)
    v_mfma_f32_32x32x16_bf16 v[52:67], v[32:35], v[28:31], v[52:67]
    ds_read_b128 v[40:43], v19 offset:24576
    ds_read_b64_tr_b16 v[44:45], v20 offset:36864
    ds_read_b64_tr_b16 v[46:47], v20 offset:37888
    s_waitcnt lgkmcnt(3)
    v_mfma_f32_32x32x16_bf16 v[68:83], v[36:39], v[28:31], v[68:83]
    ds_read_b64_tr_b16 v[48:49], v21 offset:36864
    ds_read_b64_tr_b16 v[50:51], v21 offset:37888
    s_waitcnt lgkmcnt(2)
    v_mfma_f32_32x32x16_bf16 v[52:67], v[44:47], v[40:43], v[52:67]
    s_waitcnt lgkmcnt(0)
    v_mfma_f32_32x32x16_bf16 v[68:83], v[48:51], v[40:43], v[68:83]
    s_setprio 0
    s_waitcnt vmcnt(2)
    s_barrier
    s_setprio 3
    ds_read_b128 v[28:31], v16 offset:49152
    ds_read_b64_tr_b16 v[32:33], v20 offset:49152
    ds_read_b64_tr_b16 v[34:35], v20 offset:50176
    ds_read_b64_tr_b16 v[36:37], v21 offset:49152
    ds_read_b64_tr_b16 v[38:39], v21 offset:50176
    s_waitcnt lgkmcnt(2)
    v_mfma_f32_32x32x16_bf16 v[52:67], v[32:35], v[28:31], v[52:67]
    ds_read_b128 v[40:43], v17 offset:49152
    ds_read_b64_tr_b16 v[44:45], v20 offset:53248
    ds_read_b64_tr_b16 v[46:47], v20 offset:54272
    s_waitcnt lgkmcnt(3)
    v_mfma_f32_32x32x16_bf16 v[68:83], v[36:39], v[28:31], v[68:83]
    ds_read_b64_tr_b16 v[48:49], v21 offset:53248
    ds_read_b64_tr_b16 v[50:51], v21 offset:54272
    s_add_u32 m0, s60, 24576
    s_nop 0
    buffer_load_dwordx4 v10, s[4:7], s65 offen offset:0 lds
    buffer_load_dwordx4 v11, s[4:7], s65 offen offset:1024 lds
    s_add_u32 s65, s65, 128
    s_waitcnt lgkmcnt(2)
    v_mfma_f32_32x32x16_bf16 v[52:67], v[44:47], v[40:43], v[52:67]
    ds_read_b128 v[28:31], v18 offset:49152
    ds_read_b64_tr_b16 v[32:33], v20 offset:57344
    ds_read_b64_tr_b16 v[34:35], v20 offset:58368
    s_waitcnt lgkmcnt(3)
    v_mfma_f32_32x32x16_bf16 v[68:83], v[48:51], v[40:43], v[68:83]
    ds_read_b64_tr_b16 v[36:37], v21 offset:57344
    ds_read_b64_tr_b16 v[38:39], v21 offset:58368
    s_waitcnt lgkmcnt(2)
    v_mfma_f32_32x32x16_bf16 v[52:67], v[32:35], v[28:31], v[52:67]
    ds_read_b128 v[40:43], v19 offset:49152
    ds_read_b64_tr_b16 v[44:45], v20 offset:61440
    ds_read_b64_tr_b16 v[46:47], v20 offset:62464
    s_waitcnt lgkmcnt(3)
    v_mfma_f32_32x32x16_bf16 v[68:83], v[36:39], v[28:31], v[68:83]
    ds_read_b64_tr_b16 v[48:49], v21 offset:61440
    ds_read_b64_tr_b16 v[50:51], v21 offset:62464
    s_waitcnt lgkmcnt(2)
    v_mfma_f32_32x32x16_bf16 v[52:67], v[44:47], v[40:43], v[52:67]
    s_waitcnt lgkmcnt(0)
    v_mfma_f32_32x32x16_bf16 v[68:83], v[48:51], v[40:43], v[68:83]
    s_setprio 0
    s_sub_u32 s69, s69, 1
    s_cmp_lg_u32 s69, 0
    s_cbranch_scc1 k2_kernel_g_s1
    s_waitcnt vmcnt(2)
    s_barrier
    s_setprio 3
    ds_read_b128 v[28:31], v16 offset:0
    ds_read_b64_tr_b16 v[32:33], v20 offset:0
    ds_read_b64_tr_b16 v[34:35], v20 offset:1024
    ds_read_b64_tr_b16 v[36:37], v21 offset:0
    ds_read_b64_tr_b16 v[38:39], v21 offset:1024
    s_waitcnt lgkmcnt(2)
    v_mfma_f32_32x32x16_bf16 v[52:67], v[32:35], v[28:31], v[52:67]
    ds_read_b128 v[40:43], v17 offset:0
    ds_read_b64_tr_b16 v[44:45], v20 offset:4096
    ds_read_b64_tr_b16 v[46:47], v20 offset:5120
    s_waitcnt lgkmcnt(3)
    v_mfma_f32_32x32x16_bf16 v[68:83], v[36:39], v[28:31], v[68:83]
    ds_read_b64_tr_b16 v[48:49], v21 offset:4096
    ds_read_b64_tr_b16 v[50:51], v21 offset:5120
    s_add_u32 m0, s60, 49152
    s_nop 0
    buffer_load_dwordx4 v10, s[4:7], s65 offen offset:0 lds
    buffer_load_dwordx4 v11, s[4:7], s65 offen offset:1024 lds
    s_add_u32 s65, s65, 128
    s_waitcnt lgkmcnt(2)
    v_mfma_f32_32x32x16_bf16 v[52:67], v[44:47], v[40:43], v[52:67]
    ds_read_b128 v[28:31], v18 offset:0
    ds_read_b64_tr_b16 v[32:33], v20 offset:8192
    ds_read_b64_tr_b16 v[34:35], v20 offset:9216
    s_waitcnt lgkmcnt(3)
    v_mfma_f32_32x32x16_bf16 v[68:83], v[48:51], v[40:43], v[68:83]
    ds_read_b64_tr_b16 v[36:37], v21 offset:8192
    ds_read_b64_tr_b16 v[38:39], v21 offset:9216
    s_waitcnt lgkmcnt(2)
    v_mfma_f32_32x32x16_bf16 v[52:67], v[32:35], v[28:31], v[52:67]
    ds_read_b128 v[40:43], v19 offset:0
    ds_read_b64_tr_b16 v[44:45], v20 offset:12288
    ds_read_b64_tr_b16 v[46:47], v20 offset:13312
    s_waitcnt lgkmcnt(3)
    v_mfma_f32_32x32x16_bf16 v[68:83], v[36:39], v[28:31], v[68:83]
    ds_read_b64_tr_b16 v[48:49], v21 offset:12288
    ds_read_b64_tr_b16 v[50:51], v21 offset:13312
    s_waitcnt lgkmcnt(2)
    v_mfma_f32_32x32x16_bf16 v[52:67], v[44:47], v[40:43], v[52:67]
    s_waitcnt lgkmcnt(0)
    v_mfma_f32_32x32x16_bf16 v[68:83], v[48:51], v[40:43], v[68:83]
    s_setprio 0
    s_waitcnt vmcnt(2)
    s_barrier
    s_setprio 3
    ds_read_b128 v[28:31], v16 offset:24576
    ds_read_b64_tr_b16 v[32:33], v20 offset:24576
    ds_read_b64_tr_b16 v[34:35], v20 offset:25600
    ds_read_b64_tr_b16 v[36:37], v21 offset:24576
    ds_read_b64_tr_b16 v[38:39], v21 offset:25600
    s_waitcnt lgkmcnt(2)
    v_mfma_f32_32x32x16_bf16 v[52:67], v[32:35], v[28:31], v[52:67]
    ds_read_b128 v[40:43], v17 offset:24576
    ds_read_b64_tr_b16 v[44:45], v20 offset:28672
    ds_read_b64_tr_b16 v[46:47], v20 offset:29696
    s_waitcnt lgkmcnt(3)
    v_mfma_f32_32x32x16_bf16 v[68:83], v[36:39], v[28:31], v[68:83]
    ds_read_b64_tr_b16 v[48:49], v21 offset:28672
    ds_read_b64_tr_b16 v[50:51], v21 offset:29696
    s_add_u32 m0, s60, 0
    s_nop 0
    buffer_load_dwordx4 v10, s[4:7], s65 offen offset:0 lds
    buffer_load_dwordx4 v11, s[4:7], s65 offen offset:1024 lds
    s_add_u32 s65, s65, 128
    s_waitcnt lgkmcnt(2)
    v_mfma_f32_32x32x16_bf16 v[52:67], v[44:47], v[40:43], v[52:67]
    ds_read_b128 v[28:31], v18 offset:24576
    ds_read_b64_tr_b16 v[32:33], v20 offset:32768
    ds_read_b64_tr_b16 v[34:35], v20 offset:33792
    s_waitcnt lgkmcnt(3)
    v_mfma_f32_32x32x16_bf16 v[68:83], v[48:51], v[40:43], v[68:83]
    ds_read_b64_tr_b16 v[36:37], v21 offset:32768
    ds_read_b64_tr_b16 v[38:39], v21 offset:33792
    s_waitcnt lgkmcnt(2)
    v_mfma_f32_32x32x16_bf16 v[52:67], v[32:35], v[28:31], v[52:67]
    ds_read_b128 v[40:43], v19 offset:24576
    ds_read_b64_tr_b16 v[44:45], v20 offset:36864
    ds_read_b64_tr_b16 v[46:47], v20 offset:37888
    s_waitcnt lgkmcnt(3)
    v_mfma_f32_32x32x16_bf16 v[68:83], v[36:39], v[28:31], v[68:83]
    ds_read_b64_tr_b16 v[48:49], v21 offset:36864
    ds_read_b64_tr_b16 v[50:51], v21 offset:37888
    s_waitcnt lgkmcnt(2)
    v_mfma_f32_32x32x16_bf16 v[52:67], v[44:47], v[40:43], v[52:67]
    s_waitcnt lgkmcnt(0)
    v_mfma_f32_32x32x16_bf16 v[68:83], v[48:51], v[40:43], v[68:83]
    s_setprio 0
    s_mov_b32 s65, 0
    s_waitcnt vmcnt(2)
    s_barrier
    s_setprio 3
    ds_read_b128 v[28:31], v16 offset:49152
    ds_read_b64_tr_b16 v[32:33], v20 offset:49152
    ds_read_b64_tr_b16 v[34:35], v20 offset:50176
    ds_read_b64_tr_b16 v[36:37], v21 offset:49152
    ds_read_b64_tr_b16 v[38:39], v21 offset:50176
    s_waitcnt lgkmcnt(2)
    v_mfma_f32_32x32x16_bf16 v[52:67], v[32:35], v[28:31], v[52:67]
    ds_read_b128 v[40:43], v17 offset:49152
    ds_read_b64_tr_b16 v[44:45], v20 offset:53248
    ds_read_b64_tr_b16 v[46:47], v20 offset:54272
    s_waitcnt lgkmcnt(3)
    v_mfma_f32_32x32x16_bf16 v[68:83], v[36:39], v[28:31], v[68:83]
    ds_read_b64_tr_b16 v[48:49], v21 offset:53248
    ds_read_b64_tr_b16 v[50:51], v21 offset:54272
    s_add_u32 m0, s60, 24576
    s_nop 0
    buffer_load_dwordx4 v12, s[8:11], s65 offen offset:0 lds
    buffer_load_dwordx4 v13, s[8:11], s65 offen offset:1024 lds
    s_add_u32 s65, s65, 128
    s_waitcnt lgkmcnt(2)
    v_mfma_f32_32x32x16_bf16 v[52:67], v[44:47], v[40:43], v[52:67]
    ds_read_b128 v[28:31], v18 offset:49152
    ds_read_b64_tr_b16 v[32:33], v20 offset:57344
    ds_read_b64_tr_b16 v[34:35], v20 offset:58368
    s_waitcnt lgkmcnt(3)
    v_mfma_f32_32x32x16_bf16 v[68:83], v[48:51], v[40:43], v[68:83]
    ds_read_b64_tr_b16 v[36:37], v21 offset:57344
    ds_read_b64_tr_b16 v[38:39], v21 offset:58368
    s_waitcnt lgkmcnt(2)
    v_mfma_f32_32x32x16_bf16 v[52:67], v[32:35], v[28:31], v[52:67]
    ds_read_b128 v[40:43], v19 offset:49152
    ds_read_b64_tr_b16 v[44:45], v20 offset:61440
    ds_read_b64_tr_b16 v[46:47], v20 offset:62464
    s_waitcnt lgkmcnt(3)
    v_mfma_f32_32x32x16_bf16 v[68:83], v[36:39], v[28:31], v[68:83]
    ds_read_b64_tr_b16 v[48:49], v21 offset:61440
    ds_read_b64_tr_b16 v[50:51], v21 offset:62464
    s_waitcnt lgkmcnt(2)
    v_mfma_f32_32x32x16_bf16 v[52:67], v[44:47], v[40:43], v[52:67]
    s_waitcnt lgkmcnt(0)
    v_mfma_f32_32x32x16_bf16 v[68:83], v[48:51], v[40:43], v[68:83]
    s_setprio 0
    s_waitcnt vmcnt(2)
    s_barrier
    s_setprio 3
    ds_read_b128 v[28:31], v16 offset:0
    ds_read_b64_tr_b16 v[32:33], v20 offset:0
    ds_read_b64_tr_b16 v[34:35], v20 offset:1024
    ds_read_b64_tr_b16 v[36:37], v21 offset:0
    ds_read_b64_tr_b16 v[38:39], v21 offset:1024
    s_waitcnt lgkmcnt(2)
    v_mfma_f32_32x32x16_bf16 v[52:67], v[32:35], v[28:31], v[52:67]
    ds_read_b128 v[40:43], v17 offset:0
    ds_read_b64_tr_b16 v[44:45], v20 offset:4096
    ds_read_b64_tr_b16 v[46:47], v20 offset:5120
    s_waitcnt lgkmcnt(3)
    v_mfma_f32_32x32x16_bf16 v[68:83], v[36:39], v[28:31], v[68:83]
    ds_read_b64_tr_b16 v[48:49], v21 offset:4096
    ds_read_b64_tr_b16 v[50:51], v21 offset:5120
    s_add_u32 m0, s60, 49152
    s_nop 0
    buffer_load_dwordx4 v12, s[8:11], s65 offen offset:0 lds
    buffer_load_dwordx4 v13, s[8:11], s65 offen offset:1024 lds
    s_add_u32 s65, s65, 128
    s_waitcnt lgkmcnt(2)
    v_mfma_f32_32x32x16_bf16 v[52:67], v[44:47], v[40:43], v[52:67]
    ds_read_b128 v[28:31], v18 offset:0
    ds_read_b64_tr_b16 v[32:33], v20 offset:8192
    ds_read_b64_tr_b16 v[34:35], v20 offset:9216
    s_waitcnt lgkmcnt(3)
    v_mfma_f32_32x32x16_bf16 v[68:83], v[48:51], v[40:43], v[68:83]
    ds_read_b64_tr_b16 v[36:37], v21 offset:8192
    ds_read_b64_tr_b16 v[38:39], v21 offset:9216
    s_waitcnt lgkmcnt(2)
    v_mfma_f32_32x32x16_bf16 v[52:67], v[32:35], v[28:31], v[52:67]
    ds_read_b128 v[40:43], v19 offset:0
    ds_read_b64_tr_b16 v[44:45], v20 offset:12288
    ds_read_b64_tr_b16 v[46:47], v20 offset:13312
    s_waitcnt lgkmcnt(3)
    v_mfma_f32_32x32x16_bf16 v[68:83], v[36:39], v[28:31], v[68:83]
    ds_read_b64_tr_b16 v[48:49], v21 offset:12288
    ds_read_b64_tr_b16 v[50:51], v21 offset:13312
    s_waitcnt lgkmcnt(2)
    v_mfma_f32_32x32x16_bf16 v[52:67], v[44:47], v[40:43], v[52:67]
    s_waitcnt lgkmcnt(0)
    v_mfma_f32_32x32x16_bf16 v[68:83], v[48:51], v[40:43], v[68:83]
    s_setprio 0
    s_mov_b32 s69, 10
.p2align 6
k2_kernel_g_s2:
    s_waitcnt vmcnt(2)
    s_barrier
    s_setprio 3
    ds_read_b128 v[28:31], v16 offset:24576
    ds_read_b64_tr_b16 v[32:33], v20 offset:24576
    ds_read_b64_tr_b16 v[34:35], v20 offset:25600
    ds_read_b64_tr_b16 v[36:37], v21 offset:24576
    ds_read_b64_tr_b16 v[38:39], v21 offset:25600
    s_waitcnt lgkmcnt(2)
    v_mfma_f32_32x32x16_bf16 v[84:99], v[32:35], v[28:31], v[84:99]
    ds_read_b128 v[40:43], v17 offset:24576
    ds_read_b64_tr_b16 v[44:45], v20 offset:28672
    ds_read_b64_tr_b16 v[46:47], v20 offset:29696
    s_waitcnt lgkmcnt(3)
    v_mfma_f32_32x32x16_bf16 v[100:115], v[36:39], v[28:31], v[100:115]
    ds_read_b64_tr_b16 v[48:49], v21 offset:28672
    ds_read_b64_tr_b16 v[50:51], v21 offset:29696
    s_add_u32 m0, s60, 0
    s_nop 0
    buffer_load_dwordx4 v12, s[8:11], s65 offen offset:0 lds
    buffer_load_dwordx4 v13, s[8:11], s65 offen offset:1024 lds
    s_add_u32 s65, s65, 128
    s_waitcnt lgkmcnt(2)
    v_mfma_f32_32x32x16_bf16 v[84:99], v[44:47], v[40:43], v[84:99]
    ds_read_b128 v[28:31], v18 offset:24576
    ds_read_b64_tr_b16 v[32:33], v20 offset:32768
    ds_read_b64_tr_b16 v[34:35], v20 offset:33792
    s_waitcnt lgkmcnt(3)
    v_mfma_f32_32x32x16_bf16 v[100:115], v[48:51], v[40:43], v[100:115]
    ds_read_b64_tr_b16 v[36:37], v21 offset:32768
    ds_read_b64_tr_b16 v[38:39], v21 offset:33792
    s_waitcnt lgkmcnt(2)
    v_mfma_f32_32x32x16_bf16 v[84:99], v[32:35], v[28:31], v[84:99]
    ds_read_b128 v[40:43], v19 offset:24576
    ds_read_b64_tr_b16 v[44:45], v20 offset:36864
    ds_read_b64_tr_b16 v[46:47], v20 offset:37888
    s_waitcnt lgkmcnt(3)
    v_mfma_f32_32x32x16_bf16 v[100:115], v[36:39], v[28:31], v[100:115]
    ds_read_b64_tr_b16 v[48:49], v21 offset:36864
    ds_read_b64_tr_b16 v[50:51], v21 offset:37888
    s_waitcnt lgkmcnt(2)
    v_mfma_f32_32x32x16_bf16 v[84:99], v[44:47], v[40:43], v[84:99]
    s_waitcnt lgkmcnt(0)
    v_mfma_f32_32x32x16_bf16 v[100:115], v[48:51], v[40:43], v[100:115]
    s_setprio 0
    s_waitcnt vmcnt(2)
    s_barrier
    s_setprio 3
    ds_read_b128 v[28:31], v16 offset:49152
    ds_read_b64_tr_b16 v[32:33], v20 offset:49152
    ds_read_b64_tr_b16 v[34:35], v20 offset:50176
    ds_read_b64_tr_b16 v[36:37], v21 offset:49152
    ds_read_b64_tr_b16 v[38:39], v21 offset:50176
    s_waitcnt lgkmcnt(2)
    v_mfma_f32_32x32x16_bf16 v[84:99], v[32:35], v[28:31], v[84:99]
    ds_read_b128 v[40:43], v17 offset:49152
    ds_read_b64_tr_b16 v[44:45], v20 offset:53248
    ds_read_b64_tr_b16 v[46:47], v20 offset:54272
    s_waitcnt lgkmcnt(3)
    v_mfma_f32_32x32x16_bf16 v[100:115], v[36:39], v[28:31], v[100:115]
    ds_read_b64_tr_b16 v[48:49], v21 offset:53248
    ds_read_b64_tr_b16 v[50:51], v21 offset:54272
    s_add_u32 m0, s60, 24576
    s_nop 0
    buffer_load_dwordx4 v12, s[8:11], s65 offen offset:0 lds
    buffer_load_dwordx4 v13, s[8:11], s65 offen offset:1024 lds
    s_add_u32 s65, s65, 128
    s_waitcnt lgkmcnt(2)
    v_mfma_f32_32x32x16_bf16 v[84:99], v[44:47], v[40:43], v[84:99]
    ds_read_b128 v[28:31], v18 offset:49152
    ds_read_b64_tr_b16 v[32:33], v20 offset:57344
    ds_read_b64_tr_b16 v[34:35], v20 offset:58368
    s_waitcnt lgkmcnt(3)
    v_mfma_f32_32x32x16_bf16 v[100:115], v[48:51], v[40:43], v[100:115]
    ds_read_b64_tr_b16 v[36:37], v21 offset:57344
    ds_read_b64_tr_b16 v[38:39], v21 offset:58368
    s_waitcnt lgkmcnt(2)
    v_mfma_f32_32x32x16_bf16 v[84:99], v[32:35], v[28:31], v[84:99]
    ds_read_b128 v[40:43], v19 offset:49152
    ds_read_b64_tr_b16 v[44:45], v20 offset:61440
    ds_read_b64_tr_b16 v[46:47], v20 offset:62464
    s_waitcnt lgkmcnt(3)
    v_mfma_f32_32x32x16_bf16 v[100:115], v[36:39], v[28:31], v[100:115]
    ds_read_b64_tr_b16 v[48:49], v21 offset:61440
    ds_read_b64_tr_b16 v[50:51], v21 offset:62464
    s_waitcnt lgkmcnt(2)
    v_mfma_f32_32x32x16_bf16 v[84:99], v[44:47], v[40:43], v[84:99]
    s_waitcnt lgkmcnt(0)
    v_mfma_f32_32x32x16_bf16 v[100:115], v[48:51], v[40:43], v[100:115]
    s_setprio 0
    s_waitcnt vmcnt(2)
    s_barrier
    s_setprio 3
    ds_read_b128 v[28:31], v16 offset:0
    ds_read_b64_tr_b16 v[32:33], v20 offset:0
    ds_read_b64_tr_b16 v[34:35], v20 offset:1024
    ds_read_b64_tr_b16 v[36:37], v21 offset:0
    ds_read_b64_tr_b16 v[38:39], v21 offset:1024
    s_waitcnt lgkmcnt(2)
    v_mfma_f32_32x32x16_bf16 v[84:99], v[32:35], v[28:31], v[84:99]
    ds_read_b128 v[40:43], v17 offset:0
    ds_read_b64_tr_b16 v[44:45], v20 offset:4096
    ds_read_b64_tr_b16 v[46:47], v20 offset:5120
    s_waitcnt lgkmcnt(3)
    v_mfma_f32_32x32x16_bf16 v[100:115], v[36:39], v[28:31], v[100:115]
    ds_read_b64_tr_b16 v[48:49], v21 offset:4096
    ds_read_b64_tr_b16 v[50:51], v21 offset:5120
    s_add_u32 m0, s60, 49152
    s_nop 0
    buffer_load_dwordx4 v12, s[8:11], s65 offen offset:0 lds
    buffer_load_dwordx4 v13, s[8:11], s65 offen offset:1024 lds
    s_add_u32 s65, s65, 128
    s_waitcnt lgkmcnt(2)
    v_mfma_f32_32x32x16_bf16 v[84:99], v[44:47], v[40:43], v[84:99]
    ds_read_b128 v[28:31], v18 offset:0
    ds_read_b64_tr_b16 v[32:33], v20 offset:8192
    ds_read_b64_tr_b16 v[34:35], v20 offset:9216
    s_waitcnt lgkmcnt(3)
    v_mfma_f32_32x32x16_bf16 v[100:115], v[48:51], v[40:43], v[100:115]
    ds_read_b64_tr_b16 v[36:37], v21 offset:8192
    ds_read_b64_tr_b16 v[38:39], v21 offset:9216
    s_waitcnt lgkmcnt(2)
    v_mfma_f32_32x32x16_bf16 v[84:99], v[32:35], v[28:31], v[84:99]
    ds_read_b128 v[40:43], v19 offset:0
    ds_read_b64_tr_b16 v[44:45], v20 offset:12288
    ds_read_b64_tr_b16 v[46:47], v20 offset:13312
    s_waitcnt lgkmcnt(3)
    v_mfma_f32_32x32x16_bf16 v[100:115], v[36:39], v[28:31], v[100:115]
    ds_read_b64_tr_b16 v[48:49], v21 offset:12288
    ds_read_b64_tr_b16 v[50:51], v21 offset:13312
    s_waitcnt lgkmcnt(2)
    v_mfma_f32_32x32x16_bf16 v[84:99], v[44:47], v[40:43], v[84:99]
    s_waitcnt lgkmcnt(0)
    v_mfma_f32_32x32x16_bf16 v[100:115], v[48:51], v[40:43], v[100:115]
    s_setprio 0
    s_sub_u32 s69, s69, 1
    s_cmp_lg_u32 s69, 0
    s_cbranch_scc1 k2_kernel_g_s2
    s_waitcnt vmcnt(2)
    s_barrier
    s_setprio 3
    ds_read_b128 v[28:31], v16 offset:24576
    ds_read_b64_tr_b16 v[32:33], v20 offset:24576
    ds_read_b64_tr_b16 v[34:35], v20 offset:25600
    ds_read_b64_tr_b16 v[36:37], v21 offset:24576
    ds_read_b64_tr_b16 v[38:39], v21 offset:25600
    s_waitcnt lgkmcnt(2)
    v_mfma_f32_32x32x16_bf16 v[84:99], v[32:35], v[28:31], v[84:99]
    ds_read_b128 v[40:43], v17 offset:24576
    ds_read_b64_tr_b16 v[44:45], v20 offset:28672
    ds_read_b64_tr_b16 v[46:47], v20 offset:29696
    s_waitcnt lgkmcnt(3)
    v_mfma_f32_32x32x16_bf16 v[100:115], v[36:39], v[28:31], v[100:115]
    ds_read_b64_tr_b16 v[48:49], v21 offset:28672
    ds_read_b64_tr_b16 v[50:51], v21 offset:29696
    s_waitcnt lgkmcnt(2)
    v_mfma_f32_32x32x16_bf16 v[84:99], v[44:47], v[40:43], v[84:99]
    ds_read_b128 v[28:31], v18 offset:24576
    ds_read_b64_tr_b16 v[32:33], v20 offset:32768
    ds_read_b64_tr_b16 v[34:35], v20 offset:33792
    s_waitcnt lgkmcnt(3)
    v_mfma_f32_32x32x16_bf16 v[100:115], v[48:51], v[40:43], v[100:115]
    ds_read_b64_tr_b16 v[36:37], v21 offset:32768
    ds_read_b64_tr_b16 v[38:39], v21 offset:33792
    s_waitcnt lgkmcnt(2)
    v_mfma_f32_32x32x16_bf16 v[84:99], v[32:35], v[28:31], v[84:99]
    ds_read_b128 v[40:43], v19 offset:24576
    ds_read_b64_tr_b16 v[44:45], v20 offset:36864
    ds_read_b64_tr_b16 v[46:47], v20 offset:37888
    s_waitcnt lgkmcnt(3)
    v_mfma_f32_32x32x16_bf16 v[100:115], v[36:39], v[28:31], v[100:115]
    ds_read_b64_tr_b16 v[48:49], v21 offset:36864
    ds_read_b64_tr_b16 v[50:51], v21 offset:37888
    s_waitcnt lgkmcnt(2)
    v_mfma_f32_32x32x16_bf16 v[84:99], v[44:47], v[40:43], v[84:99]
    s_waitcnt lgkmcnt(0)
    v_mfma_f32_32x32x16_bf16 v[100:115], v[48:51], v[40:43], v[100:115]
    s_setprio 0
    s_waitcnt vmcnt(0)
    s_barrier
    s_setprio 3
    ds_read_b128 v[28:31], v16 offset:49152
    ds_read_b64_tr_b16 v[32:33], v20 offset:49152
    ds_read_b64_tr_b16 v[34:35], v20 offset:50176
    ds_read_b64_tr_b16 v[36:37], v21 offset:49152
    ds_read_b64_tr_b16 v[38:39], v21 offset:50176
    s_waitcnt lgkmcnt(2)
    v_mfma_f32_32x32x16_bf16 v[84:99], v[32:35], v[28:31], v[84:99]
    ds_read_b128 v[40:43], v17 offset:49152
    ds_read_b64_tr_b16 v[44:45], v20 offset:53248
    ds_read_b64_tr_b16 v[46:47], v20 offset:54272
    s_waitcnt lgkmcnt(3)
    v_mfma_f32_32x32x16_bf16 v[100:115], v[36:39], v[28:31], v[100:115]
    ds_read_b64_tr_b16 v[48:49], v21 offset:53248
    ds_read_b64_tr_b16 v[50:51], v21 offset:54272
    s_waitcnt lgkmcnt(2)
    v_mfma_f32_32x32x16_bf16 v[84:99], v[44:47], v[40:43], v[84:99]
    ds_read_b128 v[28:31], v18 offset:49152
    ds_read_b64_tr_b16 v[32:33], v20 offset:57344
    ds_read_b64_tr_b16 v[34:35], v20 offset:58368
    s_waitcnt lgkmcnt(3)
    v_mfma_f32_32x32x16_bf16 v[100:115], v[48:51], v[40:43], v[100:115]
    ds_read_b64_tr_b16 v[36:37], v21 offset:57344
    ds_read_b64_tr_b16 v[38:39], v21 offset:58368
    s_waitcnt lgkmcnt(2)
    v_mfma_f32_32x32x16_bf16 v[84:99], v[32:35], v[28:31], v[84:99]
    ds_read_b128 v[40:43], v19 offset:49152
    ds_read_b64_tr_b16 v[44:45], v20 offset:61440
    ds_read_b64_tr_b16 v[46:47], v20 offset:62464
    s_waitcnt lgkmcnt(3)
    v_mfma_f32_32x32x16_bf16 v[100:115], v[36:39], v[28:31], v[100:115]
    ds_read_b64_tr_b16 v[48:49], v21 offset:61440
    ds_read_b64_tr_b16 v[50:51], v21 offset:62464
    s_waitcnt lgkmcnt(2)
    v_mfma_f32_32x32x16_bf16 v[84:99], v[44:47], v[40:43], v[84:99]
    s_waitcnt lgkmcnt(0)
    v_mfma_f32_32x32x16_bf16 v[100:115], v[48:51], v[40:43], v[100:115]
    s_setprio 0
    s_mov_b32 s62, 0
    s_setprio 1
    s_lshl_b32 s31, s29, 7
    s_add_u32 s31, s31, s28
    s_movk_i32 s32, 1792
    v_mul_lo_u32 v6, v2, s32
    v_lshl_add_u32 v6, v3, 4, v6
    v_add_u32 v6, s31, v6
    v_mov_b32 v10, 0xbdd2d3e8
    v_mov_b32 v11, 0xbdd2d3e8
    v_mov_b32 v12, 0xc0135761
    v_mov_b32 v13, 0xc0135761
    v_mov_b32 v14, 1.0
    v_mov_b32 v15, 1.0
    s_waitcnt vmcnt(0)
    v_lshlrev_b32 v9, 16, v9
    s_nop 7
    s_lshl_b32 s36, s21, 12
    s_add_u32 s36, s36, s62
    v_and_b32 v7, 31, v1
    v_bfe_u32 v5, v1, 1, 3
    v_lshrrev_b32 v8, 5, v1
    v_xor_b32 v5, v5, v8
    v_lshlrev_b32 v7, 7, v7
    v_add_u32 v7, s36, v7
    v_pk_mul_f32 v[28:29], v[52:53], v[52:53]
    v_pk_mul_f32 v[30:31], v[54:55], v[54:55]
    v_pk_mul_f32 v[32:33], v[56:57], v[56:57]
    v_pk_mul_f32 v[34:35], v[58:59], v[58:59]
    v_pk_mul_f32 v[36:37], v[60:61], v[60:61]
    v_pk_mul_f32 v[38:39], v[62:63], v[62:63]
    v_pk_mul_f32 v[40:41], v[64:65], v[64:65]
    v_pk_mul_f32 v[42:43], v[66:67], v[66:67]
    v_pk_fma_f32 v[28:29], v[28:29], v[10:11], v[12:13]
    v_pk_fma_f32 v[30:31], v[30:31], v[10:11], v[12:13]
    v_pk_fma_f32 v[32:33], v[32:33], v[10:11], v[12:13]
    v_pk_fma_f32 v[34:35], v[34:35], v[10:11], v[12:13]
    v_pk_fma_f32 v[36:37], v[36:37], v[10:11], v[12:13]
    v_pk_fma_f32 v[38:39], v[38:39], v[10:11], v[12:13]
    v_pk_fma_f32 v[40:41], v[40:41], v[10:11], v[12:13]
    v_pk_fma_f32 v[42:43], v[42:43], v[10:11], v[12:13]
    v_pk_mul_f32 v[28:29], v[28:29], v[52:53]
    v_pk_mul_f32 v[30:31], v[30:31], v[54:55]
    v_pk_mul_f32 v[32:33], v[32:33], v[56:57]
    v_pk_mul_f32 v[34:35], v[34:35], v[58:59]
    v_pk_mul_f32 v[36:37], v[36:37], v[60:61]
    v_pk_mul_f32 v[38:39], v[38:39], v[62:63]
    v_pk_mul_f32 v[40:41], v[40:41], v[64:65]
    v_pk_mul_f32 v[42:43], v[42:43], v[66:67]
    v_exp_f32 v28, v28
    v_exp_f32 v29, v29
    v_exp_f32 v30, v30
    v_exp_f32 v31, v31
    v_exp_f32 v32, v32
    v_exp_f32 v33, v33
    v_exp_f32 v34, v34
    v_exp_f32 v35, v35
    v_exp_f32 v36, v36
    v_exp_f32 v37, v37
    v_exp_f32 v38, v38
    v_exp_f32 v39, v39
    v_exp_f32 v40, v40
    v_exp_f32 v41, v41
    v_exp_f32 v42, v42
    v_exp_f32 v43, v43
    s_nop 0
    v_pk_add_f32 v[28:29], v[28:29], v[14:15]
    v_pk_add_f32 v[30:31], v[30:31], v[14:15]
    v_pk_add_f32 v[32:33], v[32:33], v[14:15]
    v_pk_add_f32 v[34:35], v[34:35], v[14:15]
    v_pk_add_f32 v[36:37], v[36:37], v[14:15]
    v_pk_add_f32 v[38:39], v[38:39], v[14:15]
    v_pk_add_f32 v[40:41], v[40:41], v[14:15]
    v_pk_add_f32 v[42:43], v[42:43], v[14:15]
    v_rcp_f32 v28, v28
    v_rcp_f32 v29, v29
    v_rcp_f32 v30, v30
    v_rcp_f32 v31, v31
    v_rcp_f32 v32, v32
    v_rcp_f32 v33, v33
    v_rcp_f32 v34, v34
    v_rcp_f32 v35, v35
    v_rcp_f32 v36, v36
    v_rcp_f32 v37, v37
    v_rcp_f32 v38, v38
    v_rcp_f32 v39, v39
    v_rcp_f32 v40, v40
    v_rcp_f32 v41, v41
    v_rcp_f32 v42, v42
    v_rcp_f32 v43, v43
    s_nop 0
    v_pk_mul_f32 v[52:53], v[52:53], v[28:29]
    v_pk_mul_f32 v[54:55], v[54:55], v[30:31]
    v_pk_mul_f32 v[56:57], v[56:57], v[32:33]
    v_pk_mul_f32 v[58:59], v[58:59], v[34:35]
    v_pk_mul_f32 v[60:61], v[60:61], v[36:37]
    v_pk_mul_f32 v[62:63], v[62:63], v[38:39]
    v_pk_mul_f32 v[64:65], v[64:65], v[40:41]
    v_pk_mul_f32 v[66:67], v[66:67], v[42:43]
    v_add_f32 v84, v84, v9
    v_add_f32 v85, v85, v9
    v_add_f32 v86, v86, v9
    v_add_f32 v87, v87, v9
    v_add_f32 v88, v88, v9
    v_add_f32 v89, v89, v9
    v_add_f32 v90, v90, v9
    v_add_f32 v91, v91, v9
    v_add_f32 v92, v92, v9
    v_add_f32 v93, v93, v9
    v_add_f32 v94, v94, v9
    v_add_f32 v95, v95, v9
    v_add_f32 v96, v96, v9
    v_add_f32 v97, v97, v9
    v_add_f32 v98, v98, v9
    v_add_f32 v99, v99, v9
    v_pk_mul_f32 v[52:53], v[52:53], v[84:85]
    v_pk_mul_f32 v[54:55], v[54:55], v[86:87]
    v_pk_mul_f32 v[56:57], v[56:57], v[88:89]
    v_pk_mul_f32 v[58:59], v[58:59], v[90:91]
    v_pk_mul_f32 v[60:61], v[60:61], v[92:93]
    v_pk_mul_f32 v[62:63], v[62:63], v[94:95]
    v_pk_mul_f32 v[64:65], v[64:65], v[96:97]
    v_pk_mul_f32 v[66:67], v[66:67], v[98:99]
    v_cvt_pk_bf16_f32 v44, v52, v53
    v_cvt_pk_bf16_f32 v45, v54, v55
    v_cvt_pk_bf16_f32 v46, v56, v57
    v_cvt_pk_bf16_f32 v47, v58, v59
    v_xor_b32 v8, 0, v5
    v_lshl_add_u32 v8, v8, 4, v7
    ds_write_b128 v8, v[44:47]
    v_cvt_pk_bf16_f32 v48, v60, v61
    v_cvt_pk_bf16_f32 v49, v62, v63
    v_cvt_pk_bf16_f32 v50, v64, v65
    v_cvt_pk_bf16_f32 v51, v66, v67
    v_xor_b32 v8, 2, v5
    v_lshl_add_u32 v8, v8, 4, v7
    ds_write_b128 v8, v[48:51]
    s_nop 1
    v_pk_mul_f32 v[28:29], v[68:69], v[68:69]
    v_pk_mul_f32 v[30:31], v[70:71], v[70:71]
    v_pk_mul_f32 v[32:33], v[72:73], v[72:73]
    v_pk_mul_f32 v[34:35], v[74:75], v[74:75]
    v_pk_mul_f32 v[36:37], v[76:77], v[76:77]
    v_pk_mul_f32 v[38:39], v[78:79], v[78:79]
    v_pk_mul_f32 v[40:41], v[80:81], v[80:81]
    v_pk_mul_f32 v[42:43], v[82:83], v[82:83]
    v_pk_fma_f32 v[28:29], v[28:29], v[10:11], v[12:13]
    v_pk_fma_f32 v[30:31], v[30:31], v[10:11], v[12:13]
    v_pk_fma_f32 v[32:33], v[32:33], v[10:11], v[12:13]
    v_pk_fma_f32 v[34:35], v[34:35], v[10:11], v[12:13]
    v_pk_fma_f32 v[36:37], v[36:37], v[10:11], v[12:13]
    v_pk_fma_f32 v[38:39], v[38:39], v[10:11], v[12:13]
    v_pk_fma_f32 v[40:41], v[40:41], v[10:11], v[12:13]
    v_pk_fma_f32 v[42:43], v[42:43], v[10:11], v[12:13]
    v_pk_mul_f32 v[28:29], v[28:29], v[68:69]
    v_pk_mul_f32 v[30:31], v[30:31], v[70:71]
    v_pk_mul_f32 v[32:33], v[32:33], v[72:73]
    v_pk_mul_f32 v[34:35], v[34:35], v[74:75]
    v_pk_mul_f32 v[36:37], v[36:37], v[76:77]
    v_pk_mul_f32 v[38:39], v[38:39], v[78:79]
    v_pk_mul_f32 v[40:41], v[40:41], v[80:81]
    v_pk_mul_f32 v[42:43], v[42:43], v[82:83]
    v_exp_f32 v28, v28
    v_exp_f32 v29, v29
    v_exp_f32 v30, v30
    v_exp_f32 v31, v31
    v_exp_f32 v32, v32
    v_exp_f32 v33, v33
    v_exp_f32 v34, v34
    v_exp_f32 v35, v35
    v_exp_f32 v36, v36
    v_exp_f32 v37, v37
    v_exp_f32 v38, v38
    v_exp_f32 v39, v39
    v_exp_f32 v40, v40
    v_exp_f32 v41, v41
    v_exp_f32 v42, v42
    v_exp_f32 v43, v43
    s_nop 0
    v_pk_add_f32 v[28:29], v[28:29], v[14:15]
    v_pk_add_f32 v[30:31], v[30:31], v[14:15]
    v_pk_add_f32 v[32:33], v[32:33], v[14:15]
    v_pk_add_f32 v[34:35], v[34:35], v[14:15]
    v_pk_add_f32 v[36:37], v[36:37], v[14:15]
    v_pk_add_f32 v[38:39], v[38:39], v[14:15]
    v_pk_add_f32 v[40:41], v[40:41], v[14:15]
    v_pk_add_f32 v[42:43], v[42:43], v[14:15]
    v_rcp_f32 v28, v28
    v_rcp_f32 v29, v29
    v_rcp_f32 v30, v30
    v_rcp_f32 v31, v31
    v_rcp_f32 v32, v32
    v_rcp_f32 v33, v33
    v_rcp_f32 v34, v34
    v_rcp_f32 v35, v35
    v_rcp_f32 v36, v36
    v_rcp_f32 v37, v37
    v_rcp_f32 v38, v38
    v_rcp_f32 v39, v39
    v_rcp_f32 v40, v40
    v_rcp_f32 v41, v41
    v_rcp_f32 v42, v42
    v_rcp_f32 v43, v43
    s_nop 0
    v_pk_mul_f32 v[68:69], v[68:69], v[28:29]
    v_pk_mul_f32 v[70:71], v[70:71], v[30:31]
    v_pk_mul_f32 v[72:73], v[72:73], v[32:33]
    v_pk_mul_f32 v[74:75], v[74:75], v[34:35]
    v_pk_mul_f32 v[76:77], v[76:77], v[36:37]
    v_pk_mul_f32 v[78:79], v[78:79], v[38:39]
    v_pk_mul_f32 v[80:81], v[80:81], v[40:41]
    v_pk_mul_f32 v[82:83], v[82:83], v[42:43]
    v_add_f32 v100, v100, v9
    v_add_f32 v101, v101, v9
    v_add_f32 v102, v102, v9
    v_add_f32 v103, v103, v9
    v_add_f32 v104, v104, v9
    v_add_f32 v105, v105, v9
    v_add_f32 v106, v106, v9
    v_add_f32 v107, v107, v9
    v_add_f32 v108, v108, v9
    v_add_f32 v109, v109, v9
    v_add_f32 v110, v110, v9
    v_add_f32 v111, v111, v9
    v_add_f32 v112, v112, v9
    v_add_f32 v113, v113, v9
    v_add_f32 v114, v114, v9
    v_add_f32 v115, v115, v9
    v_pk_mul_f32 v[68:69], v[68:69], v[100:101]
    v_pk_mul_f32 v[70:71], v[70:71], v[102:103]
    v_pk_mul_f32 v[72:73], v[72:73], v[104:105]
    v_pk_mul_f32 v[74:75], v[74:75], v[106:107]
    v_pk_mul_f32 v[76:77], v[76:77], v[108:109]
    v_pk_mul_f32 v[78:79], v[78:79], v[110:111]
    v_pk_mul_f32 v[80:81], v[80:81], v[112:113]
    v_pk_mul_f32 v[82:83], v[82:83], v[114:115]
    s_cmp_eq_u32 s24, 6
    s_cselect_b32 s33, s29, 0
    s_cmp_eq_u32 s33, 0
    s_cbranch_scc1 k2_kernel_nz_7
    v_mov_b32 v68, 0
    v_mov_b32 v69, 0
    v_mov_b32 v70, 0
    v_mov_b32 v71, 0
    v_mov_b32 v72, 0
    v_mov_b32 v73, 0
    v_mov_b32 v74, 0
    v_mov_b32 v75, 0
    v_mov_b32 v76, 0
    v_mov_b32 v77, 0
    v_mov_b32 v78, 0
    v_mov_b32 v79, 0
    v_mov_b32 v80, 0
    v_mov_b32 v81, 0
    v_mov_b32 v82, 0
    v_mov_b32 v83, 0
k2_kernel_nz_7:
    v_cvt_pk_bf16_f32 v44, v68, v69
    v_cvt_pk_bf16_f32 v45, v70, v71
    v_cvt_pk_bf16_f32 v46, v72, v73
    v_cvt_pk_bf16_f32 v47, v74, v75
    v_xor_b32 v8, 4, v5
    v_lshl_add_u32 v8, v8, 4, v7
    ds_write_b128 v8, v[44:47]
    v_cvt_pk_bf16_f32 v48, v76, v77
    v_cvt_pk_bf16_f32 v49, v78, v79
    v_cvt_pk_bf16_f32 v50, v80, v81
    v_cvt_pk_bf16_f32 v51, v82, v83
    v_xor_b32 v8, 6, v5
    v_lshl_add_u32 v8, v8, 4, v7
    ds_write_b128 v8, v[48:51]
    s_nop 1
    s_waitcnt lgkmcnt(0)
    v_lshlrev_b32 v8, 4, v1
    v_add_u32 v5, s36, v8
    ds_read_b128 v[28:31], v5 offset:0
    ds_read_b128 v[32:35], v5 offset:1024
    ds_read_b128 v[36:39], v5 offset:2048
    ds_read_b128 v[40:43], v5 offset:3072
    s_mul_i32 s31, s23, 14
    s_lshl_b32 s32, s24, 1
    s_add_u32 s31, s31, s32
    s_add_u32 s31, s31, s29
    s_lshl_b32 s31, s31, 13
    s_lshl_b32 s32, s22, 12
    s_add_u32 s31, s31, s32
    v_add_u32 v8, s31, v8
    s_waitcnt lgkmcnt(0)
    buffer_store_dwordx4 v[28:31], v8, s[16:19], 0 offen offset:0 sc1
    buffer_store_dwordx4 v[32:35], v8, s[16:19], 0 offen offset:1024 sc1
    buffer_store_dwordx4 v[36:39], v8, s[16:19], 0 offen offset:2048 sc1
    buffer_store_dwordx4 v[40:43], v8, s[16:19], 0 offen offset:3072 sc1
    s_waitcnt vmcnt(0)
    s_setprio 0
    s_barrier
    s_add_u32 s12, s46, 30408704
    s_addc_u32 s13, s47, 0
    s_mov_b32 s14, 16384
    s_mov_b32 s15, 0x20000
    s_cmp_lg_u32 s20, 0
    s_cbranch_scc1 k2_kernel_t_nf
    s_lshl_b32 s30, s23, 7
    s_add_u32 s30, s30, 4096
    v_mov_b32 v2, s30
    v_mov_b32 v3, 1
    s_mov_b64 exec, 1
    buffer_atomic_add v3, v2, s[12:15], 0 offen sc1
    s_mov_b64 exec, -1
k2_kernel_t_nf:
    v_and_b32 v2, 31, v1
    s_lshl_b32 s30, s22, 5
    v_add_u32 v2, s30, v2
    v_lshlrev_b32 v2, 7, v2
    v_lshrrev_b32 v3, 5, v1
    v_bfe_u32 v4, v1, 1, 3
    v_or_b32 v5, 0, v3
    v_xor_b32 v5, v5, v4
    v_lshl_add_u32 v10, v5, 4, v2
    v_or_b32 v5, 2, v3
    v_xor_b32 v5, v5, v4
    v_lshl_add_u32 v11, v5, 4, v2
    v_or_b32 v5, 4, v3
    v_xor_b32 v5, v5, v4
    v_lshl_add_u32 v12, v5, 4, v2
    v_or_b32 v5, 6, v3
    v_xor_b32 v5, v5, v4
    v_lshl_add_u32 v13, v5, 4, v2
    v_lshrrev_b32 v2, 5, v1
    v_bfe_u32 v3, v1, 2, 2
    v_lshl_add_u32 v4, v2, 3, v3
    v_mul_u32_u24 v4, 192, v4
    v_bfe_u32 v5, v1, 4, 1
    v_lshl_add_u32 v4, v5, 5, v4
    v_and_b32 v5, 1, v1
    v_lshl_add_u32 v4, v5, 4, v4
    v_bfe_u32 v5, v1, 1, 1
    v_lshl_add_u32 v4, v5, 3, v4
    s_lshl_b32 s30, s29, 7
    s_add_u32 s30, s30, 32768
    v_add_u32 v14, s30, v4
    v_add_u32 v15, 64, v14
    v_mov_b32 v60, 0
    v_mov_b32 v61, 0
    v_mov_b32 v62, 0
    v_mov_b32 v63, 0
    v_mov_b32 v64, 0
    v_mov_b32 v65, 0
    v_mov_b32 v66, 0
    v_mov_b32 v67, 0
    v_mov_b32 v68, 0
    v_mov_b32 v69, 0
    v_mov_b32 v70, 0
    v_mov_b32 v71, 0
    v_mov_b32 v72, 0
    v_mov_b32 v73, 0
    v_mov_b32 v74, 0
    v_mov_b32 v75, 0
    v_mov_b32 v76, 0
    v_mov_b32 v77, 0
    v_mov_b32 v78, 0
    v_mov_b32 v79, 0
    v_mov_b32 v80, 0
    v_mov_b32 v81, 0
    v_mov_b32 v82, 0
    v_mov_b32 v83, 0
    v_mov_b32 v84, 0
    v_mov_b32 v85, 0
    v_mov_b32 v86, 0
    v_mov_b32 v87, 0
    v_mov_b32 v88, 0
    v_mov_b32 v89, 0
    v_mov_b32 v90, 0
    v_mov_b32 v91, 0
    v_mov_b32 v92, 0
    v_mov_b32 v93, 0
    v_mov_b32 v94, 0
    v_mov_b32 v95, 0
    v_mov_b32 v96, 0
    v_mov_b32 v97, 0
    v_mov_b32 v98, 0
    v_mov_b32 v99, 0
    v_mov_b32 v100, 0
    v_mov_b32 v101, 0
    v_mov_b32 v102, 0
    v_mov_b32 v103, 0
    v_mov_b32 v104, 0
    v_mov_b32 v105, 0
    v_mov_b32 v106, 0
    v_mov_b32 v107, 0
    v_mov_b32 v108, 0
    v_mov_b32 v109, 0
    v_mov_b32 v110, 0
    v_mov_b32 v111, 0
    v_mov_b32 v112, 0
    v_mov_b32 v113, 0
    v_mov_b32 v114, 0
    v_mov_b32 v115, 0
    v_mov_b32 v116, 0
    v_mov_b32 v117, 0
    v_mov_b32 v118, 0
    v_mov_b32 v119, 0
    v_mov_b32 v120, 0
    v_mov_b32 v121, 0
    v_mov_b32 v122, 0
    v_mov_b32 v123, 0
    s_mov_b32 s62, 0
    s_mov_b32 s63, 20480
    s_mov_b32 s64, 40960
    s_mov_b32 s65, 61440
    s_add_u32 s8, s46, 29360128
    s_addc_u32 s9, s47, 0
    s_mov_b32 s10, 8192
    s_mov_b32 s11, 0x20000
    s_mov_b32 s16, s78
    s_mov_b32 s17, s79
    s_mov_b32 s18, 2621440
    s_mov_b32 s19, 0x20000
    v_and_b32 v2, 31, v1
    s_lshl_b32 s30, s22, 5
    s_add_u32 s30, s30, s27
    v_add_u32 v2, s30, v2
    v_lshlrev_b32 v4, 2, v2
    buffer_load_dword v6, v4, s[8:11], 0 offen
    s_barrier
    s_cmp_eq_u32 s29, 0
    s_cbranch_scc0 k2_kernel_t1
    s_mov_b32 s35, 3
k2_kernel_t2b:
    s_barrier
    s_setprio 1
    ds_read_b128 v[24:27], v10 offset:0
    ds_read_b64_tr_b16 v[28:29], v14 offset:0
    ds_read_b64_tr_b16 v[30:31], v14 offset:768
    ds_read_b64_tr_b16 v[32:33], v15 offset:0
    ds_read_b64_tr_b16 v[34:35], v15 offset:768
    ds_read_b128 v[36:39], v11 offset:0
    ds_read_b64_tr_b16 v[40:41], v14 offset:3072
    ds_read_b64_tr_b16 v[42:43], v14 offset:3840
    ds_read_b64_tr_b16 v[44:45], v15 offset:3072
    ds_read_b64_tr_b16 v[46:47], v15 offset:3840
    ds_read_b128 v[48:51], v12 offset:0
    ds_read_b64_tr_b16 v[52:53], v14 offset:6144
    ds_read_b64_tr_b16 v[54:55], v14 offset:6912
    ds_read_b64_tr_b16 v[56:57], v15 offset:6144
    ds_read_b64_tr_b16 v[58:59], v15 offset:6912
    s_waitcnt lgkmcnt(10)
    v_mfma_f32_32x32x16_bf16 v[60:75], v[28:31], v[24:27], v[60:75]
    v_mfma_f32_32x32x16_bf16 v[76:91], v[32:35], v[24:27], v[76:91]
    ds_read_b128 v[24:27], v13 offset:0
    ds_read_b64_tr_b16 v[28:29], v14 offset:9216
    ds_read_b64_tr_b16 v[30:31], v14 offset:9984
    ds_read_b64_tr_b16 v[32:33], v15 offset:9216
    ds_read_b64_tr_b16 v[34:35], v15 offset:9984
    s_waitcnt lgkmcnt(10)
    v_mfma_f32_32x32x16_bf16 v[60:75], v[40:43], v[36:39], v[60:75]
    v_mfma_f32_32x32x16_bf16 v[76:91], v[44:47], v[36:39], v[76:91]
    s_waitcnt lgkmcnt(5)
    v_mfma_f32_32x32x16_bf16 v[60:75], v[52:55], v[48:51], v[60:75]
    v_mfma_f32_32x32x16_bf16 v[76:91], v[56:59], v[48:51], v[76:91]
    s_waitcnt lgkmcnt(0)
    v_mfma_f32_32x32x16_bf16 v[60:75], v[28:31], v[24:27], v[60:75]
    v_mfma_f32_32x32x16_bf16 v[76:91], v[32:35], v[24:27], v[76:91]
    s_setprio 0
    s_barrier
    s_setprio 1
    ds_read_b128 v[24:27], v10 offset:8192
    ds_read_b64_tr_b16 v[28:29], v14 offset:12288
    ds_read_b64_tr_b16 v[30:31], v14 offset:13056
    ds_read_b64_tr_b16 v[32:33], v15 offset:12288
    ds_read_b64_tr_b16 v[34:35], v15 offset:13056
    ds_read_b128 v[36:39], v11 offset:8192
    ds_read_b64_tr_b16 v[40:41], v14 offset:15360
    ds_read_b64_tr_b16 v[42:43], v14 offset:16128
    ds_read_b64_tr_b16 v[44:45], v15 offset:15360
    ds_read_b64_tr_b16 v[46:47], v15 offset:16128
    ds_read_b128 v[48:51], v12 offset:8192
    ds_read_b64_tr_b16 v[52:53], v14 offset:18432
    ds_read_b64_tr_b16 v[54:55], v14 offset:19200
    ds_read_b64_tr_b16 v[56:57], v15 offset:18432
    ds_read_b64_tr_b16 v[58:59], v15 offset:19200
    s_waitcnt lgkmcnt(10)
    v_mfma_f32_32x32x16_bf16 v[60:75], v[28:31], v[24:27], v[60:75]
    v_mfma_f32_32x32x16_bf16 v[76:91], v[32:35], v[24:27], v[76:91]
    ds_read_b128 v[24:27], v13 offset:8192
    ds_read_b64_tr_b16 v[28:29], v14 offset:21504
    ds_read_b64_tr_b16 v[30:31], v14 offset:22272
    ds_read_b64_tr_b16 v[32:33], v15 offset:21504
    ds_read_b64_tr_b16 v[34:35], v15 offset:22272
    s_waitcnt lgkmcnt(10)
    v_mfma_f32_32x32x16_bf16 v[60:75], v[40:43], v[36:39], v[60:75]
    v_mfma_f32_32x32x16_bf16 v[76:91], v[44:47], v[36:39], v[76:91]
    s_waitcnt lgkmcnt(5)
    v_mfma_f32_32x32x16_bf16 v[60:75], v[52:55], v[48:51], v[60:75]
    v_mfma_f32_32x32x16_bf16 v[76:91], v[56:59], v[48:51], v[76:91]
    s_waitcnt lgkmcnt(0)
    v_mfma_f32_32x32x16_bf16 v[60:75], v[28:31], v[24:27], v[60:75]
    v_mfma_f32_32x32x16_bf16 v[76:91], v[32:35], v[24:27], v[76:91]
    s_setprio 0
    s_barrier
    s_setprio 1
    ds_read_b128 v[24:27], v10 offset:16384
    ds_read_b64_tr_b16 v[28:29], v14 offset:24576
    ds_read_b64_tr_b16 v[30:31], v14 offset:25344
    ds_read_b64_tr_b16 v[32:33], v15 offset:24576
    ds_read_b64_tr_b16 v[34:35], v15 offset:25344
    ds_read_b128 v[36:39], v11 offset:16384
    ds_read_b64_tr_b16 v[40:41], v14 offset:27648
    ds_read_b64_tr_b16 v[42:43], v14 offset:28416
    ds_read_b64_tr_b16 v[44:45], v15 offset:27648
    ds_read_b64_tr_b16 v[46:47], v15 offset:28416
    ds_read_b128 v[48:51], v12 offset:16384
    ds_read_b64_tr_b16 v[52:53], v14 offset:30720
    ds_read_b64_tr_b16 v[54:55], v14 offset:31488
    ds_read_b64_tr_b16 v[56:57], v15 offset:30720
    ds_read_b64_tr_b16 v[58:59], v15 offset:31488
    s_waitcnt lgkmcnt(10)
    v_mfma_f32_32x32x16_bf16 v[60:75], v[28:31], v[24:27], v[60:75]
    v_mfma_f32_32x32x16_bf16 v[76:91], v[32:35], v[24:27], v[76:91]
    ds_read_b128 v[24:27], v13 offset:16384
    ds_read_b64_tr_b16 v[28:29], v14 offset:33792
    ds_read_b64_tr_b16 v[30:31], v14 offset:34560
    ds_read_b64_tr_b16 v[32:33], v15 offset:33792
    ds_read_b64_tr_b16 v[34:35], v15 offset:34560
    s_waitcnt lgkmcnt(10)
    v_mfma_f32_32x32x16_bf16 v[60:75], v[40:43], v[36:39], v[60:75]
    v_mfma_f32_32x32x16_bf16 v[76:91], v[44:47], v[36:39], v[76:91]
    s_waitcnt lgkmcnt(5)
    v_mfma_f32_32x32x16_bf16 v[60:75], v[52:55], v[48:51], v[60:75]
    v_mfma_f32_32x32x16_bf16 v[76:91], v[56:59], v[48:51], v[76:91]
    s_waitcnt lgkmcnt(0)
    v_mfma_f32_32x32x16_bf16 v[60:75], v[28:31], v[24:27], v[60:75]
    v_mfma_f32_32x32x16_bf16 v[76:91], v[32:35], v[24:27], v[76:91]
    s_setprio 0
    s_barrier
    s_setprio 1
    ds_read_b128 v[24:27], v10 offset:24576
    ds_read_b64_tr_b16 v[28:29], v14 offset:36864
    ds_read_b64_tr_b16 v[30:31], v14 offset:37632
    ds_read_b64_tr_b16 v[32:33], v15 offset:36864
    ds_read_b64_tr_b16 v[34:35], v15 offset:37632
    ds_read_b128 v[36:39], v11 offset:24576
    ds_read_b64_tr_b16 v[40:41], v14 offset:39936
    ds_read_b64_tr_b16 v[42:43], v14 offset:40704
    ds_read_b64_tr_b16 v[44:45], v15 offset:39936
    ds_read_b64_tr_b16 v[46:47], v15 offset:40704
    ds_read_b128 v[48:51], v12 offset:24576
    ds_read_b64_tr_b16 v[52:53], v14 offset:43008
    ds_read_b64_tr_b16 v[54:55], v14 offset:43776
    ds_read_b64_tr_b16 v[56:57], v15 offset:43008
    ds_read_b64_tr_b16 v[58:59], v15 offset:43776
    s_waitcnt lgkmcnt(10)
    v_mfma_f32_32x32x16_bf16 v[60:75], v[28:31], v[24:27], v[60:75]
    v_mfma_f32_32x32x16_bf16 v[76:91], v[32:35], v[24:27], v[76:91]
    ds_read_b128 v[24:27], v13 offset:24576
    ds_read_b64_tr_b16 v[28:29], v14 offset:46080
    ds_read_b64_tr_b16 v[30:31], v14 offset:46848
    ds_read_b64_tr_b16 v[32:33], v15 offset:46080
    ds_read_b64_tr_b16 v[34:35], v15 offset:46848
    s_waitcnt lgkmcnt(10)
    v_mfma_f32_32x32x16_bf16 v[60:75], v[40:43], v[36:39], v[60:75]
    v_mfma_f32_32x32x16_bf16 v[76:91], v[44:47], v[36:39], v[76:91]
    s_waitcnt lgkmcnt(5)
    v_mfma_f32_32x32x16_bf16 v[60:75], v[52:55], v[48:51], v[60:75]
    v_mfma_f32_32x32x16_bf16 v[76:91], v[56:59], v[48:51], v[76:91]
    s_waitcnt lgkmcnt(0)
    v_mfma_f32_32x32x16_bf16 v[60:75], v[28:31], v[24:27], v[60:75]
    v_mfma_f32_32x32x16_bf16 v[76:91], v[32:35], v[24:27], v[76:91]
    s_setprio 0
    s_sub_u32 s35, s35, 1
    s_cmp_lg_u32 s35, 0
    s_cbranch_scc1 k2_kernel_t2b
    s_barrier
    s_setprio 1
    ds_read_b128 v[24:27], v10 offset:0
    ds_read_b64_tr_b16 v[28:29], v14 offset:0
    ds_read_b64_tr_b16 v[30:31], v14 offset:768
    ds_read_b64_tr_b16 v[32:33], v15 offset:0
    ds_read_b64_tr_b16 v[34:35], v15 offset:768
    ds_read_b128 v[36:39], v11 offset:0
    ds_read_b64_tr_b16 v[40:41], v14 offset:3072
    ds_read_b64_tr_b16 v[42:43], v14 offset:3840
    ds_read_b64_tr_b16 v[44:45], v15 offset:3072
    ds_read_b64_tr_b16 v[46:47], v15 offset:3840
    ds_read_b128 v[48:51], v12 offset:0
    ds_read_b64_tr_b16 v[52:53], v14 offset:6144
    ds_read_b64_tr_b16 v[54:55], v14 offset:6912
    ds_read_b64_tr_b16 v[56:57], v15 offset:6144
    ds_read_b64_tr_b16 v[58:59], v15 offset:6912
    s_waitcnt lgkmcnt(10)
    v_mfma_f32_32x32x16_bf16 v[60:75], v[28:31], v[24:27], v[60:75]
    v_mfma_f32_32x32x16_bf16 v[76:91], v[32:35], v[24:27], v[76:91]
    ds_read_b128 v[24:27], v13 offset:0
    ds_read_b64_tr_b16 v[28:29], v14 offset:9216
    ds_read_b64_tr_b16 v[30:31], v14 offset:9984
    ds_read_b64_tr_b16 v[32:33], v15 offset:9216
    ds_read_b64_tr_b16 v[34:35], v15 offset:9984
    s_waitcnt lgkmcnt(10)
    v_mfma_f32_32x32x16_bf16 v[60:75], v[40:43], v[36:39], v[60:75]
    v_mfma_f32_32x32x16_bf16 v[76:91], v[44:47], v[36:39], v[76:91]
    s_waitcnt lgkmcnt(5)
    v_mfma_f32_32x32x16_bf16 v[60:75], v[52:55], v[48:51], v[60:75]
    v_mfma_f32_32x32x16_bf16 v[76:91], v[56:59], v[48:51], v[76:91]
    s_waitcnt lgkmcnt(0)
    v_mfma_f32_32x32x16_bf16 v[60:75], v[28:31], v[24:27], v[60:75]
    v_mfma_f32_32x32x16_bf16 v[76:91], v[32:35], v[24:27], v[76:91]
    s_setprio 0
    s_barrier
    s_setprio 1
    ds_read_b128 v[24:27], v10 offset:8192
    ds_read_b64_tr_b16 v[28:29], v14 offset:12288
    ds_read_b64_tr_b16 v[30:31], v14 offset:13056
    ds_read_b64_tr_b16 v[32:33], v15 offset:12288
    ds_read_b64_tr_b16 v[34:35], v15 offset:13056
    ds_read_b128 v[36:39], v11 offset:8192
    ds_read_b64_tr_b16 v[40:41], v14 offset:15360
    ds_read_b64_tr_b16 v[42:43], v14 offset:16128
    ds_read_b64_tr_b16 v[44:45], v15 offset:15360
    ds_read_b64_tr_b16 v[46:47], v15 offset:16128
    ds_read_b128 v[48:51], v12 offset:8192
    ds_read_b64_tr_b16 v[52:53], v14 offset:18432
    ds_read_b64_tr_b16 v[54:55], v14 offset:19200
    ds_read_b64_tr_b16 v[56:57], v15 offset:18432
    ds_read_b64_tr_b16 v[58:59], v15 offset:19200
    s_waitcnt lgkmcnt(10)
    v_mfma_f32_32x32x16_bf16 v[60:75], v[28:31], v[24:27], v[60:75]
    v_mfma_f32_32x32x16_bf16 v[76:91], v[32:35], v[24:27], v[76:91]
    ds_read_b128 v[24:27], v13 offset:8192
    ds_read_b64_tr_b16 v[28:29], v14 offset:21504
    ds_read_b64_tr_b16 v[30:31], v14 offset:22272
    ds_read_b64_tr_b16 v[32:33], v15 offset:21504
    ds_read_b64_tr_b16 v[34:35], v15 offset:22272
    s_waitcnt lgkmcnt(10)
    v_mfma_f32_32x32x16_bf16 v[60:75], v[40:43], v[36:39], v[60:75]
    v_mfma_f32_32x32x16_bf16 v[76:91], v[44:47], v[36:39], v[76:91]
    s_waitcnt lgkmcnt(5)
    v_mfma_f32_32x32x16_bf16 v[60:75], v[52:55], v[48:51], v[60:75]
    v_mfma_f32_32x32x16_bf16 v[76:91], v[56:59], v[48:51], v[76:91]
    s_waitcnt lgkmcnt(0)
    v_mfma_f32_32x32x16_bf16 v[60:75], v[28:31], v[24:27], v[60:75]
    v_mfma_f32_32x32x16_bf16 v[76:91], v[32:35], v[24:27], v[76:91]
    s_setprio 0
    s_barrier
    s_mov_b32 s35, 3
k2_kernel_t2a:
    s_barrier
    s_setprio 1
    ds_read_b128 v[24:27], v10 offset:16384
    ds_read_b64_tr_b16 v[28:29], v14 offset:24576
    ds_read_b64_tr_b16 v[30:31], v14 offset:25344
    ds_read_b64_tr_b16 v[32:33], v15 offset:24576
    ds_read_b64_tr_b16 v[34:35], v15 offset:25344
    ds_read_b128 v[36:39], v11 offset:16384
    ds_read_b64_tr_b16 v[40:41], v14 offset:27648
    ds_read_b64_tr_b16 v[42:43], v14 offset:28416
    ds_read_b64_tr_b16 v[44:45], v15 offset:27648
    ds_read_b64_tr_b16 v[46:47], v15 offset:28416
    ds_read_b128 v[48:51], v12 offset:16384
    ds_read_b64_tr_b16 v[52:53], v14 offset:30720
    ds_read_b64_tr_b16 v[54:55], v14 offset:31488
    ds_read_b64_tr_b16 v[56:57], v15 offset:30720
    ds_read_b64_tr_b16 v[58:59], v15 offset:31488
    s_waitcnt lgkmcnt(10)
    v_mfma_f32_32x32x16_bf16 v[92:107], v[28:31], v[24:27], v[92:107]
    v_mfma_f32_32x32x16_bf16 v[108:123], v[32:35], v[24:27], v[108:123]
    ds_read_b128 v[24:27], v13 offset:16384
    ds_read_b64_tr_b16 v[28:29], v14 offset:33792
    ds_read_b64_tr_b16 v[30:31], v14 offset:34560
    ds_read_b64_tr_b16 v[32:33], v15 offset:33792
    ds_read_b64_tr_b16 v[34:35], v15 offset:34560
    s_waitcnt lgkmcnt(10)
    v_mfma_f32_32x32x16_bf16 v[92:107], v[40:43], v[36:39], v[92:107]
    v_mfma_f32_32x32x16_bf16 v[108:123], v[44:47], v[36:39], v[108:123]
    s_waitcnt lgkmcnt(5)
    v_mfma_f32_32x32x16_bf16 v[92:107], v[52:55], v[48:51], v[92:107]
    v_mfma_f32_32x32x16_bf16 v[108:123], v[56:59], v[48:51], v[108:123]
    s_waitcnt lgkmcnt(0)
    v_mfma_f32_32x32x16_bf16 v[92:107], v[28:31], v[24:27], v[92:107]
    v_mfma_f32_32x32x16_bf16 v[108:123], v[32:35], v[24:27], v[108:123]
    s_setprio 0
    s_barrier
    s_setprio 1
    ds_read_b128 v[24:27], v10 offset:24576
    ds_read_b64_tr_b16 v[28:29], v14 offset:36864
    ds_read_b64_tr_b16 v[30:31], v14 offset:37632
    ds_read_b64_tr_b16 v[32:33], v15 offset:36864
    ds_read_b64_tr_b16 v[34:35], v15 offset:37632
    ds_read_b128 v[36:39], v11 offset:24576
    ds_read_b64_tr_b16 v[40:41], v14 offset:39936
    ds_read_b64_tr_b16 v[42:43], v14 offset:40704
    ds_read_b64_tr_b16 v[44:45], v15 offset:39936
    ds_read_b64_tr_b16 v[46:47], v15 offset:40704
    ds_read_b128 v[48:51], v12 offset:24576
    ds_read_b64_tr_b16 v[52:53], v14 offset:43008
    ds_read_b64_tr_b16 v[54:55], v14 offset:43776
    ds_read_b64_tr_b16 v[56:57], v15 offset:43008
    ds_read_b64_tr_b16 v[58:59], v15 offset:43776
    s_waitcnt lgkmcnt(10)
    v_mfma_f32_32x32x16_bf16 v[92:107], v[28:31], v[24:27], v[92:107]
    v_mfma_f32_32x32x16_bf16 v[108:123], v[32:35], v[24:27], v[108:123]
    ds_read_b128 v[24:27], v13 offset:24576
    ds_read_b64_tr_b16 v[28:29], v14 offset:46080
    ds_read_b64_tr_b16 v[30:31], v14 offset:46848
    ds_read_b64_tr_b16 v[32:33], v15 offset:46080
    ds_read_b64_tr_b16 v[34:35], v15 offset:46848
    s_waitcnt lgkmcnt(10)
    v_mfma_f32_32x32x16_bf16 v[92:107], v[40:43], v[36:39], v[92:107]
    v_mfma_f32_32x32x16_bf16 v[108:123], v[44:47], v[36:39], v[108:123]
    s_waitcnt lgkmcnt(5)
    v_mfma_f32_32x32x16_bf16 v[92:107], v[52:55], v[48:51], v[92:107]
    v_mfma_f32_32x32x16_bf16 v[108:123], v[56:59], v[48:51], v[108:123]
    s_waitcnt lgkmcnt(0)
    v_mfma_f32_32x32x16_bf16 v[92:107], v[28:31], v[24:27], v[92:107]
    v_mfma_f32_32x32x16_bf16 v[108:123], v[32:35], v[24:27], v[108:123]
    s_setprio 0
    s_barrier
    s_setprio 1
    ds_read_b128 v[24:27], v10 offset:0
    ds_read_b64_tr_b16 v[28:29], v14 offset:0
    ds_read_b64_tr_b16 v[30:31], v14 offset:768
    ds_read_b64_tr_b16 v[32:33], v15 offset:0
    ds_read_b64_tr_b16 v[34:35], v15 offset:768
    ds_read_b128 v[36:39], v11 offset:0
    ds_read_b64_tr_b16 v[40:41], v14 offset:3072
    ds_read_b64_tr_b16 v[42:43], v14 offset:3840
    ds_read_b64_tr_b16 v[44:45], v15 offset:3072
    ds_read_b64_tr_b16 v[46:47], v15 offset:3840
    ds_read_b128 v[48:51], v12 offset:0
    ds_read_b64_tr_b16 v[52:53], v14 offset:6144
    ds_read_b64_tr_b16 v[54:55], v14 offset:6912
    ds_read_b64_tr_b16 v[56:57], v15 offset:6144
    ds_read_b64_tr_b16 v[58:59], v15 offset:6912
    s_waitcnt lgkmcnt(10)
    v_mfma_f32_32x32x16_bf16 v[92:107], v[28:31], v[24:27], v[92:107]
    v_mfma_f32_32x32x16_bf16 v[108:123], v[32:35], v[24:27], v[108:123]
    ds_read_b128 v[24:27], v13 offset:0
    ds_read_b64_tr_b16 v[28:29], v14 offset:9216
    ds_read_b64_tr_b16 v[30:31], v14 offset:9984
    ds_read_b64_tr_b16 v[32:33], v15 offset:9216
    ds_read_b64_tr_b16 v[34:35], v15 offset:9984
    s_waitcnt lgkmcnt(10)
    v_mfma_f32_32x32x16_bf16 v[92:107], v[40:43], v[36:39], v[92:107]
    v_mfma_f32_32x32x16_bf16 v[108:123], v[44:47], v[36:39], v[108:123]
    s_waitcnt lgkmcnt(5)
    v_mfma_f32_32x32x16_bf16 v[92:107], v[52:55], v[48:51], v[92:107]
    v_mfma_f32_32x32x16_bf16 v[108:123], v[56:59], v[48:51], v[108:123]
    s_waitcnt lgkmcnt(0)
    v_mfma_f32_32x32x16_bf16 v[92:107], v[28:31], v[24:27], v[92:107]
    v_mfma_f32_32x32x16_bf16 v[108:123], v[32:35], v[24:27], v[108:123]
    s_setprio 0
    s_barrier
    s_setprio 1
    ds_read_b128 v[24:27], v10 offset:8192
    ds_read_b64_tr_b16 v[28:29], v14 offset:12288
    ds_read_b64_tr_b16 v[30:31], v14 offset:13056
    ds_read_b64_tr_b16 v[32:33], v15 offset:12288
    ds_read_b64_tr_b16 v[34:35], v15 offset:13056
    ds_read_b128 v[36:39], v11 offset:8192
    ds_read_b64_tr_b16 v[40:41], v14 offset:15360
    ds_read_b64_tr_b16 v[42:43], v14 offset:16128
    ds_read_b64_tr_b16 v[44:45], v15 offset:15360
    ds_read_b64_tr_b16 v[46:47], v15 offset:16128
    ds_read_b128 v[48:51], v12 offset:8192
    ds_read_b64_tr_b16 v[52:53], v14 offset:18432
    ds_read_b64_tr_b16 v[54:55], v14 offset:19200
    ds_read_b64_tr_b16 v[56:57], v15 offset:18432
    ds_read_b64_tr_b16 v[58:59], v15 offset:19200
    s_waitcnt lgkmcnt(10)
    v_mfma_f32_32x32x16_bf16 v[92:107], v[28:31], v[24:27], v[92:107]
    v_mfma_f32_32x32x16_bf16 v[108:123], v[32:35], v[24:27], v[108:123]
    ds_read_b128 v[24:27], v13 offset:8192
    ds_read_b64_tr_b16 v[28:29], v14 offset:21504
    ds_read_b64_tr_b16 v[30:31], v14 offset:22272
    ds_read_b64_tr_b16 v[32:33], v15 offset:21504
    ds_read_b64_tr_b16 v[34:35], v15 offset:22272
    s_waitcnt lgkmcnt(10)
    v_mfma_f32_32x32x16_bf16 v[92:107], v[40:43], v[36:39], v[92:107]
    v_mfma_f32_32x32x16_bf16 v[108:123], v[44:47], v[36:39], v[108:123]
    s_waitcnt lgkmcnt(5)
    v_mfma_f32_32x32x16_bf16 v[92:107], v[52:55], v[48:51], v[92:107]
    v_mfma_f32_32x32x16_bf16 v[108:123], v[56:59], v[48:51], v[108:123]
    s_waitcnt lgkmcnt(0)
    v_mfma_f32_32x32x16_bf16 v[92:107], v[28:31], v[24:27], v[92:107]
    v_mfma_f32_32x32x16_bf16 v[108:123], v[32:35], v[24:27], v[108:123]
    s_setprio 0
    s_sub_u32 s35, s35, 1
    s_cmp_lg_u32 s35, 0
    s_cbranch_scc1 k2_kernel_t2a
    s_branch k2_kernel_tepi
k2_kernel_t1:
    s_mov_b32 s35, 3
k2_kernel_t1b:
    s_barrier
    s_setprio 1
    ds_read_b128 v[24:27], v10 offset:0
    ds_read_b64_tr_b16 v[28:29], v14 offset:0
    ds_read_b64_tr_b16 v[30:31], v14 offset:768
    ds_read_b128 v[32:35], v11 offset:0
    ds_read_b64_tr_b16 v[36:37], v14 offset:3072
    ds_read_b64_tr_b16 v[38:39], v14 offset:3840
    ds_read_b128 v[40:43], v12 offset:0
    ds_read_b64_tr_b16 v[44:45], v14 offset:6144
    ds_read_b64_tr_b16 v[46:47], v14 offset:6912
    ds_read_b128 v[48:51], v13 offset:0
    ds_read_b64_tr_b16 v[52:53], v14 offset:9216
    ds_read_b64_tr_b16 v[54:55], v14 offset:9984
    s_waitcnt lgkmcnt(9)
    v_mfma_f32_32x32x16_bf16 v[60:75], v[28:31], v[24:27], v[60:75]
    s_waitcnt lgkmcnt(6)
    v_mfma_f32_32x32x16_bf16 v[60:75], v[36:39], v[32:35], v[60:75]
    s_waitcnt lgkmcnt(3)
    v_mfma_f32_32x32x16_bf16 v[60:75], v[44:47], v[40:43], v[60:75]
    s_waitcnt lgkmcnt(0)
    v_mfma_f32_32x32x16_bf16 v[60:75], v[52:55], v[48:51], v[60:75]
    s_setprio 0
    s_barrier
    s_setprio 1
    ds_read_b128 v[24:27], v10 offset:8192
    ds_read_b64_tr_b16 v[28:29], v14 offset:12288
    ds_read_b64_tr_b16 v[30:31], v14 offset:13056
    ds_read_b128 v[32:35], v11 offset:8192
    ds_read_b64_tr_b16 v[36:37], v14 offset:15360
    ds_read_b64_tr_b16 v[38:39], v14 offset:16128
    ds_read_b128 v[40:43], v12 offset:8192
    ds_read_b64_tr_b16 v[44:45], v14 offset:18432
    ds_read_b64_tr_b16 v[46:47], v14 offset:19200
    ds_read_b128 v[48:51], v13 offset:8192
    ds_read_b64_tr_b16 v[52:53], v14 offset:21504
    ds_read_b64_tr_b16 v[54:55], v14 offset:22272
    s_waitcnt lgkmcnt(9)
    v_mfma_f32_32x32x16_bf16 v[60:75], v[28:31], v[24:27], v[60:75]
    s_waitcnt lgkmcnt(6)
    v_mfma_f32_32x32x16_bf16 v[60:75], v[36:39], v[32:35], v[60:75]
    s_waitcnt lgkmcnt(3)
    v_mfma_f32_32x32x16_bf16 v[60:75], v[44:47], v[40:43], v[60:75]
    s_waitcnt lgkmcnt(0)
    v_mfma_f32_32x32x16_bf16 v[60:75], v[52:55], v[48:51], v[60:75]
    s_setprio 0
    s_barrier
    s_setprio 1
    ds_read_b128 v[24:27], v10 offset:16384
    ds_read_b64_tr_b16 v[28:29], v14 offset:24576
    ds_read_b64_tr_b16 v[30:31], v14 offset:25344
    ds_read_b128 v[32:35], v11 offset:16384
    ds_read_b64_tr_b16 v[36:37], v14 offset:27648
    ds_read_b64_tr_b16 v[38:39], v14 offset:28416
    ds_read_b128 v[40:43], v12 offset:16384
    ds_read_b64_tr_b16 v[44:45], v14 offset:30720
    ds_read_b64_tr_b16 v[46:47], v14 offset:31488
    ds_read_b128 v[48:51], v13 offset:16384
    ds_read_b64_tr_b16 v[52:53], v14 offset:33792
    ds_read_b64_tr_b16 v[54:55], v14 offset:34560
    s_waitcnt lgkmcnt(9)
    v_mfma_f32_32x32x16_bf16 v[60:75], v[28:31], v[24:27], v[60:75]
    s_waitcnt lgkmcnt(6)
    v_mfma_f32_32x32x16_bf16 v[60:75], v[36:39], v[32:35], v[60:75]
    s_waitcnt lgkmcnt(3)
    v_mfma_f32_32x32x16_bf16 v[60:75], v[44:47], v[40:43], v[60:75]
    s_waitcnt lgkmcnt(0)
    v_mfma_f32_32x32x16_bf16 v[60:75], v[52:55], v[48:51], v[60:75]
    s_setprio 0
    s_barrier
    s_setprio 1
    ds_read_b128 v[24:27], v10 offset:24576
    ds_read_b64_tr_b16 v[28:29], v14 offset:36864
    ds_read_b64_tr_b16 v[30:31], v14 offset:37632
    ds_read_b128 v[32:35], v11 offset:24576
    ds_read_b64_tr_b16 v[36:37], v14 offset:39936
    ds_read_b64_tr_b16 v[38:39], v14 offset:40704
    ds_read_b128 v[40:43], v12 offset:24576
    ds_read_b64_tr_b16 v[44:45], v14 offset:43008
    ds_read_b64_tr_b16 v[46:47], v14 offset:43776
    ds_read_b128 v[48:51], v13 offset:24576
    ds_read_b64_tr_b16 v[52:53], v14 offset:46080
    ds_read_b64_tr_b16 v[54:55], v14 offset:46848
    s_waitcnt lgkmcnt(9)
    v_mfma_f32_32x32x16_bf16 v[60:75], v[28:31], v[24:27], v[60:75]
    s_waitcnt lgkmcnt(6)
    v_mfma_f32_32x32x16_bf16 v[60:75], v[36:39], v[32:35], v[60:75]
    s_waitcnt lgkmcnt(3)
    v_mfma_f32_32x32x16_bf16 v[60:75], v[44:47], v[40:43], v[60:75]
    s_waitcnt lgkmcnt(0)
    v_mfma_f32_32x32x16_bf16 v[60:75], v[52:55], v[48:51], v[60:75]
    s_setprio 0
    s_sub_u32 s35, s35, 1
    s_cmp_lg_u32 s35, 0
    s_cbranch_scc1 k2_kernel_t1b
    s_barrier
    s_setprio 1
    ds_read_b128 v[24:27], v10 offset:0
    ds_read_b64_tr_b16 v[28:29], v14 offset:0
    ds_read_b64_tr_b16 v[30:31], v14 offset:768
    ds_read_b128 v[32:35], v11 offset:0
    ds_read_b64_tr_b16 v[36:37], v14 offset:3072
    ds_read_b64_tr_b16 v[38:39], v14 offset:3840
    ds_read_b128 v[40:43], v12 offset:0
    ds_read_b64_tr_b16 v[44:45], v14 offset:6144
    ds_read_b64_tr_b16 v[46:47], v14 offset:6912
    ds_read_b128 v[48:51], v13 offset:0
    ds_read_b64_tr_b16 v[52:53], v14 offset:9216
    ds_read_b64_tr_b16 v[54:55], v14 offset:9984
    s_waitcnt lgkmcnt(9)
    v_mfma_f32_32x32x16_bf16 v[60:75], v[28:31], v[24:27], v[60:75]
    s_waitcnt lgkmcnt(6)
    v_mfma_f32_32x32x16_bf16 v[60:75], v[36:39], v[32:35], v[60:75]
    s_waitcnt lgkmcnt(3)
    v_mfma_f32_32x32x16_bf16 v[60:75], v[44:47], v[40:43], v[60:75]
    s_waitcnt lgkmcnt(0)
    v_mfma_f32_32x32x16_bf16 v[60:75], v[52:55], v[48:51], v[60:75]
    s_setprio 0
    s_barrier
    s_setprio 1
    ds_read_b128 v[24:27], v10 offset:8192
    ds_read_b64_tr_b16 v[28:29], v14 offset:12288
    ds_read_b64_tr_b16 v[30:31], v14 offset:13056
    ds_read_b128 v[32:35], v11 offset:8192
    ds_read_b64_tr_b16 v[36:37], v14 offset:15360
    ds_read_b64_tr_b16 v[38:39], v14 offset:16128
    ds_read_b128 v[40:43], v12 offset:8192
    ds_read_b64_tr_b16 v[44:45], v14 offset:18432
    ds_read_b64_tr_b16 v[46:47], v14 offset:19200
    ds_read_b128 v[48:51], v13 offset:8192
    ds_read_b64_tr_b16 v[52:53], v14 offset:21504
    ds_read_b64_tr_b16 v[54:55], v14 offset:22272
    s_waitcnt lgkmcnt(9)
    v_mfma_f32_32x32x16_bf16 v[60:75], v[28:31], v[24:27], v[60:75]
    s_waitcnt lgkmcnt(6)
    v_mfma_f32_32x32x16_bf16 v[60:75], v[36:39], v[32:35], v[60:75]
    s_waitcnt lgkmcnt(3)
    v_mfma_f32_32x32x16_bf16 v[60:75], v[44:47], v[40:43], v[60:75]
    s_waitcnt lgkmcnt(0)
    v_mfma_f32_32x32x16_bf16 v[60:75], v[52:55], v[48:51], v[60:75]
    s_setprio 0
    s_barrier
    s_mov_b32 s35, 3
k2_kernel_t1a:
    s_barrier
    s_setprio 1
    ds_read_b128 v[24:27], v10 offset:16384
    ds_read_b64_tr_b16 v[28:29], v14 offset:24576
    ds_read_b64_tr_b16 v[30:31], v14 offset:25344
    ds_read_b128 v[32:35], v11 offset:16384
    ds_read_b64_tr_b16 v[36:37], v14 offset:27648
    ds_read_b64_tr_b16 v[38:39], v14 offset:28416
    ds_read_b128 v[40:43], v12 offset:16384
    ds_read_b64_tr_b16 v[44:45], v14 offset:30720
    ds_read_b64_tr_b16 v[46:47], v14 offset:31488
    ds_read_b128 v[48:51], v13 offset:16384
    ds_read_b64_tr_b16 v[52:53], v14 offset:33792
    ds_read_b64_tr_b16 v[54:55], v14 offset:34560
    s_waitcnt lgkmcnt(9)
    v_mfma_f32_32x32x16_bf16 v[92:107], v[28:31], v[24:27], v[92:107]
    s_waitcnt lgkmcnt(6)
    v_mfma_f32_32x32x16_bf16 v[92:107], v[36:39], v[32:35], v[92:107]
    s_waitcnt lgkmcnt(3)
    v_mfma_f32_32x32x16_bf16 v[92:107], v[44:47], v[40:43], v[92:107]
    s_waitcnt lgkmcnt(0)
    v_mfma_f32_32x32x16_bf16 v[92:107], v[52:55], v[48:51], v[92:107]
    s_setprio 0
    s_barrier
    s_setprio 1
    ds_read_b128 v[24:27], v10 offset:24576
    ds_read_b64_tr_b16 v[28:29], v14 offset:36864
    ds_read_b64_tr_b16 v[30:31], v14 offset:37632
    ds_read_b128 v[32:35], v11 offset:24576
    ds_read_b64_tr_b16 v[36:37], v14 offset:39936
    ds_read_b64_tr_b16 v[38:39], v14 offset:40704
    ds_read_b128 v[40:43], v12 offset:24576
    ds_read_b64_tr_b16 v[44:45], v14 offset:43008
    ds_read_b64_tr_b16 v[46:47], v14 offset:43776
    ds_read_b128 v[48:51], v13 offset:24576
    ds_read_b64_tr_b16 v[52:53], v14 offset:46080
    ds_read_b64_tr_b16 v[54:55], v14 offset:46848
    s_waitcnt lgkmcnt(9)
    v_mfma_f32_32x32x16_bf16 v[92:107], v[28:31], v[24:27], v[92:107]
    s_waitcnt lgkmcnt(6)
    v_mfma_f32_32x32x16_bf16 v[92:107], v[36:39], v[32:35], v[92:107]
    s_waitcnt lgkmcnt(3)
    v_mfma_f32_32x32x16_bf16 v[92:107], v[44:47], v[40:43], v[92:107]
    s_waitcnt lgkmcnt(0)
    v_mfma_f32_32x32x16_bf16 v[92:107], v[52:55], v[48:51], v[92:107]
    s_setprio 0
    s_barrier
    s_setprio 1
    ds_read_b128 v[24:27], v10 offset:0
    ds_read_b64_tr_b16 v[28:29], v14 offset:0
    ds_read_b64_tr_b16 v[30:31], v14 offset:768
    ds_read_b128 v[32:35], v11 offset:0
    ds_read_b64_tr_b16 v[36:37], v14 offset:3072
    ds_read_b64_tr_b16 v[38:39], v14 offset:3840
    ds_read_b128 v[40:43], v12 offset:0
    ds_read_b64_tr_b16 v[44:45], v14 offset:6144
    ds_read_b64_tr_b16 v[46:47], v14 offset:6912
    ds_read_b128 v[48:51], v13 offset:0
    ds_read_b64_tr_b16 v[52:53], v14 offset:9216
    ds_read_b64_tr_b16 v[54:55], v14 offset:9984
    s_waitcnt lgkmcnt(9)
    v_mfma_f32_32x32x16_bf16 v[92:107], v[28:31], v[24:27], v[92:107]
    s_waitcnt lgkmcnt(6)
    v_mfma_f32_32x32x16_bf16 v[92:107], v[36:39], v[32:35], v[92:107]
    s_waitcnt lgkmcnt(3)
    v_mfma_f32_32x32x16_bf16 v[92:107], v[44:47], v[40:43], v[92:107]
    s_waitcnt lgkmcnt(0)
    v_mfma_f32_32x32x16_bf16 v[92:107], v[52:55], v[48:51], v[92:107]
    s_setprio 0
    s_barrier
    s_setprio 1
    ds_read_b128 v[24:27], v10 offset:8192
    ds_read_b64_tr_b16 v[28:29], v14 offset:12288
    ds_read_b64_tr_b16 v[30:31], v14 offset:13056
    ds_read_b128 v[32:35], v11 offset:8192
    ds_read_b64_tr_b16 v[36:37], v14 offset:15360
    ds_read_b64_tr_b16 v[38:39], v14 offset:16128
    ds_read_b128 v[40:43], v12 offset:8192
    ds_read_b64_tr_b16 v[44:45], v14 offset:18432
    ds_read_b64_tr_b16 v[46:47], v14 offset:19200
    ds_read_b128 v[48:51], v13 offset:8192
    ds_read_b64_tr_b16 v[52:53], v14 offset:21504
    ds_read_b64_tr_b16 v[54:55], v14 offset:22272
    s_waitcnt lgkmcnt(9)
    v_mfma_f32_32x32x16_bf16 v[92:107], v[28:31], v[24:27], v[92:107]
    s_waitcnt lgkmcnt(6)
    v_mfma_f32_32x32x16_bf16 v[92:107], v[36:39], v[32:35], v[92:107]
    s_waitcnt lgkmcnt(3)
    v_mfma_f32_32x32x16_bf16 v[92:107], v[44:47], v[40:43], v[92:107]
    s_waitcnt lgkmcnt(0)
    v_mfma_f32_32x32x16_bf16 v[92:107], v[52:55], v[48:51], v[92:107]
    s_setprio 0
    s_sub_u32 s35, s35, 1
    s_cmp_lg_u32 s35, 0
    s_cbranch_scc1 k2_kernel_t1a
k2_kernel_tepi:
    v_lshrrev_b32 v3, 5, v1
    s_mul_i32 s28, s24, 192
    s_lshl_b32 s31, s29, 7
    s_add_u32 s31, s31, s28
    s_movk_i32 s32, 1280
    v_mul_lo_u32 v7, v2, s32
    v_lshl_add_u32 v7, v3, 4, v7
    v_add_u32 v7, s31, v7
    s_waitcnt vmcnt(0)
    v_sub_f32 v8, 1.0, v6
    s_nop 15
    s_lshl_b32 s36, s21, 12
    s_add_u32 s36, s36, 16384
    v_and_b32 v10, 31, v1
    v_lshlrev_b32 v10, 6, v10
    v_lshl_add_u32 v10, v3, 4, v10
    v_add_u32 v10, s36, v10
    v_lshlrev_b32 v11, 4, v1
    v_add_u32 v11, s36, v11
    s_lshl_b32 s33, s22, 5
    s_add_u32 s33, s33, s27
    v_lshrrev_b32 v4, 2, v1
    v_add_u32 v4, s33, v4
    v_mul_lo_u32 v4, v4, s32
    v_and_b32 v5, 3, v1
    v_lshl_add_u32 v4, v5, 4, v4
    v_add_u32 v4, s31, v4
    s_movk_i32 s35, 20480
    s_lshl_b32 s33, s29, 1
    s_add_u32 s33, s33, 0
    s_cmp_ge_u32 s33, 3
    s_cbranch_scc1 k2_kernel_oskip_8
    s_cmp_eq_u32 s24, 6
    s_cselect_b32 s34, s33, 0
    s_cmp_eq_u32 s34, 2
    s_cbranch_scc1 k2_kernel_oskip_8
    v_mul_f32 v92, v92, v6
    v_fmac_f32 v92, v60, v8
    v_mul_f32 v93, v93, v6
    v_fmac_f32 v93, v61, v8
    v_mul_f32 v94, v94, v6
    v_fmac_f32 v94, v62, v8
    v_mul_f32 v95, v95, v6
    v_fmac_f32 v95, v63, v8
    v_mul_f32 v96, v96, v6
    v_fmac_f32 v96, v64, v8
    v_mul_f32 v97, v97, v6
    v_fmac_f32 v97, v65, v8
    v_mul_f32 v98, v98, v6
    v_fmac_f32 v98, v66, v8
    v_mul_f32 v99, v99, v6
    v_fmac_f32 v99, v67, v8
    v_cvt_pk_bf16_f32 v24, v92, v93
    v_cvt_pk_bf16_f32 v25, v94, v95
    v_cvt_pk_bf16_f32 v26, v96, v97
    v_cvt_pk_bf16_f32 v27, v98, v99
    ds_write_b128 v10, v[24:27] offset:0
    v_mul_f32 v100, v100, v6
    v_fmac_f32 v100, v68, v8
    v_mul_f32 v101, v101, v6
    v_fmac_f32 v101, v69, v8
    v_mul_f32 v102, v102, v6
    v_fmac_f32 v102, v70, v8
    v_mul_f32 v103, v103, v6
    v_fmac_f32 v103, v71, v8
    v_mul_f32 v104, v104, v6
    v_fmac_f32 v104, v72, v8
    v_mul_f32 v105, v105, v6
    v_fmac_f32 v105, v73, v8
    v_mul_f32 v106, v106, v6
    v_fmac_f32 v106, v74, v8
    v_mul_f32 v107, v107, v6
    v_fmac_f32 v107, v75, v8
    v_cvt_pk_bf16_f32 v28, v100, v101
    v_cvt_pk_bf16_f32 v29, v102, v103
    v_cvt_pk_bf16_f32 v30, v104, v105
    v_cvt_pk_bf16_f32 v31, v106, v107
    ds_write_b128 v10, v[28:31] offset:32
    s_waitcnt lgkmcnt(0)
    ds_read_b128 v[32:35], v11 offset:0
    ds_read_b128 v[36:39], v11 offset:1024
    s_waitcnt lgkmcnt(0)
    buffer_store_dwordx4 v[32:35], v4, s[16:19], 0 offen offset:0 sc1
    buffer_store_dwordx4 v[36:39], v4, s[16:19], s35 offen offset:0 sc1
    s_nop 1
k2_kernel_oskip_8:
    s_lshl_b32 s33, s29, 1
    s_add_u32 s33, s33, 1
    s_cmp_ge_u32 s33, 3
    s_cbranch_scc1 k2_kernel_oskip_9
    s_cmp_eq_u32 s24, 6
    s_cselect_b32 s34, s33, 0
    s_cmp_eq_u32 s34, 2
    s_cbranch_scc1 k2_kernel_oskip_9
    v_mul_f32 v108, v108, v6
    v_fmac_f32 v108, v76, v8
    v_mul_f32 v109, v109, v6
    v_fmac_f32 v109, v77, v8
    v_mul_f32 v110, v110, v6
    v_fmac_f32 v110, v78, v8
    v_mul_f32 v111, v111, v6
    v_fmac_f32 v111, v79, v8
    v_mul_f32 v112, v112, v6
    v_fmac_f32 v112, v80, v8
    v_mul_f32 v113, v113, v6
    v_fmac_f32 v113, v81, v8
    v_mul_f32 v114, v114, v6
    v_fmac_f32 v114, v82, v8
    v_mul_f32 v115, v115, v6
    v_fmac_f32 v115, v83, v8
    v_cvt_pk_bf16_f32 v24, v108, v109
    v_cvt_pk_bf16_f32 v25, v110, v111
    v_cvt_pk_bf16_f32 v26, v112, v113
    v_cvt_pk_bf16_f32 v27, v114, v115
    ds_write_b128 v10, v[24:27] offset:2048
    v_mul_f32 v116, v116, v6
    v_fmac_f32 v116, v84, v8
    v_mul_f32 v117, v117, v6
    v_fmac_f32 v117, v85, v8
    v_mul_f32 v118, v118, v6
    v_fmac_f32 v118, v86, v8
    v_mul_f32 v119, v119, v6
    v_fmac_f32 v119, v87, v8
    v_mul_f32 v120, v120, v6
    v_fmac_f32 v120, v88, v8
    v_mul_f32 v121, v121, v6
    v_fmac_f32 v121, v89, v8
    v_mul_f32 v122, v122, v6
    v_fmac_f32 v122, v90, v8
    v_mul_f32 v123, v123, v6
    v_fmac_f32 v123, v91, v8
    v_cvt_pk_bf16_f32 v28, v116, v117
    v_cvt_pk_bf16_f32 v29, v118, v119
    v_cvt_pk_bf16_f32 v30, v120, v121
    v_cvt_pk_bf16_f32 v31, v122, v123
    ds_write_b128 v10, v[28:31] offset:2080
    s_waitcnt lgkmcnt(0)
    ds_read_b128 v[32:35], v11 offset:2048
    ds_read_b128 v[36:39], v11 offset:3072
    s_waitcnt lgkmcnt(0)
    buffer_store_dwordx4 v[32:35], v4, s[16:19], 0 offen offset:64 sc1
    buffer_store_dwordx4 v[36:39], v4, s[16:19], s35 offen offset:64 sc1
    s_nop 1
k2_kernel_oskip_9:
    s_branch k2_kernel_exit
k2_kernel_exit:
    s_endpgm
.section .rodata,"a"
.p2align 6
.amdhsa_kernel k1_kernel
  .amdhsa_next_free_vgpr 168
  .amdhsa_next_free_sgpr 102
  .amdhsa_accum_offset 168
  .amdhsa_group_segment_fixed_size 0
  .amdhsa_kernarg_size 96
  .amdhsa_user_sgpr_count 2
  .amdhsa_user_sgpr_kernarg_segment_ptr 1
  .amdhsa_system_sgpr_workgroup_id_x 1
.end_amdhsa_kernel
.section .rodata,"a"
.p2align 6
.amdhsa_kernel k2_kernel
  .amdhsa_next_free_vgpr 128
  .amdhsa_next_free_sgpr 102
  .amdhsa_accum_offset 128
  .amdhsa_group_segment_fixed_size 0
  .amdhsa_kernarg_size 96
  .amdhsa_user_sgpr_count 2
  .amdhsa_user_sgpr_kernarg_segment_ptr 1
  .amdhsa_system_sgpr_workgroup_id_x 1
.end_amdhsa_kernel
```
